```python
import torch

def _softmax(x, axis=-1):
    return torch.softmax(x, dim=axis)

def _gelu(x):
    return torch.nn.functional.gelu(x, approximate='tanh')

def _silu(x):
    return torch.nn.functional.silu(x)

def _sigmoid(x):
    return torch.sigmoid(x)

def _layernorm(x, axis=-1, eps=1e-05):
    m = x.mean(dim=axis, keepdim=True)
    v = x.var(dim=axis, keepdim=True, unbiased=False)
    return (x - m) / torch.sqrt(v + eps)

def _scatter_add(tgt, idx, src, axis=0):
    return tgt.clone().index_add_(axis, idx, src)

def _segment_sum(src, seg, n):
    out = torch.zeros((n,) + src.shape[1:], dtype=src.dtype)
    return out.index_add_(0, seg, src)

def _pad(x, pw):
    flat = tuple((v for pair in reversed(pw) for v in pair))
    return torch.nn.functional.pad(x, flat)
kernel_name = 'adaLN_cond__sliding_block_cached__swiglu_ffn__decode'

def setup_inputs():

    _w = lambda a: (lambda t: t.to(torch.bfloat16) if t.is_floating_point() else t)(torch.as_tensor(a))

    def _A_setup():
        B, Sq, D = (1, 1, 1024)
        Hq, Hkv, Sk, Dh = (32, 4, 65536, 128)
        assert Hq % Hkv == 0, (Hq, Hkv)
        return {'x': _w((lambda *s: torch.randn(*s, dtype=torch.bfloat16) * 0.1)(B, Sq, D)), 'k_cache': _w((lambda *s: torch.randn(*s, dtype=torch.bfloat16) * 0.8)(B, Hkv, Sk, Dh)), 'v_cache': _w((lambda *s: torch.randn(*s, dtype=torch.bfloat16) * 0.8)(B, Hkv, Sk, Dh)), 'wq': _w((lambda *s: torch.randn(*s, dtype=torch.bfloat16) * 0.8)(D, Hq * Dh) * D ** (-0.5)), 'wo': _w((lambda *s: torch.randn(*s, dtype=torch.bfloat16) * 0.8)(Hq * Dh, D) * (Hq * Dh) ** (-0.5))}
    _A_in = _A_setup()

    def _B_setup():
        B, S, D, F = (1, 1, 1024, 3584)
        return {'x': _w((lambda *s: torch.randn(*s, dtype=torch.bfloat16) * 0.1)(B, S, D)), 'w_gate': _w((lambda *s: torch.randn(*s, dtype=torch.bfloat16) * 0.1)(D, F)), 'w_up': _w((lambda *s: torch.randn(*s, dtype=torch.bfloat16) * 0.1)(D, F)), 'w_down': _w((lambda *s: torch.randn(*s, dtype=torch.bfloat16) * 0.1)(F, D))}
    _B_in = _B_setup()
    return {'A_x': _A_in['x'], 'A_k_cache': _A_in['k_cache'], 'A_v_cache': _A_in['v_cache'], 'A_wq': _A_in['wq'], 'A_wo': _A_in['wo'], 'B_x': _B_in['x'], 'B_w_gate': _B_in['w_gate'], 'B_w_up': _B_in['w_up'], 'B_w_down': _B_in['w_down'], 'c': _w((lambda *s: torch.randn(*s, dtype=torch.bfloat16) * 0.2)(1, 1024) * 8.0), 'w_mod': _w((lambda *s: torch.randn(*s, dtype=torch.bfloat16) * 0.2)(1024, 6 * 1024) * 1024 ** (-0.5) * 8.0)}

def reference(A_x, A_k_cache, A_v_cache, A_wq, A_wo, B_x, B_w_gate, B_w_up, B_w_down, c, w_mod):

    def _A_ref(x, k_cache, v_cache, wq, wo):
        B, Sq, D = x.shape
        Hq, Dh = (32, 128)
        Hkv, Sk = (k_cache.shape[1], k_cache.shape[2])
        W = min(4096, max(256, Sk // 4))
        rep = Hq // Hkv
        q = (lambda x, *d: x.permute(*d))((x @ wq).reshape(B, Sq, Hq, Dh), 0, 2, 1, 3)
        k = (lambda x, n, axis: torch.repeat_interleave(x, n, dim=axis))(k_cache[:, :, Sk - W:, :], rep, axis=1)
        v = (lambda x, n, axis: torch.repeat_interleave(x, n, dim=axis))(v_cache[:, :, Sk - W:, :], rep, axis=1)
        scores = torch.einsum('bhqd,bhkd->bhqk', q, k) * Dh ** (-0.5)
        p = _softmax(scores, axis=-1)
        o = torch.einsum('bhqk,bhkd->bhqd', p, v)
        return (lambda x, *d: x.permute(*d))(o, 0, 2, 1, 3).reshape(B, Sq, Hq * Dh) @ wo

    def _B_ref(x, w_gate, w_up, w_down):
        g = _silu(x @ w_gate)
        u = x @ w_up
        return g * u @ w_down
    x = A_x
    mod = (_silu(c) @ w_mod).reshape(c.shape[0], 6, 1, -1)
    sa, ca, ga, sb, cb, gb = (mod[:, 0].clone(), mod[:, 1].clone(), mod[:, 2].clone(), mod[:, 3].clone(), mod[:, 4].clone(), mod[:, 5].clone())
    h = _layernorm(x, axis=-1) * (1 + ca) + sa
    x = x + ga * _A_ref(h, A_k_cache, A_v_cache, A_wq, A_wo)
    h = _layernorm(x, axis=-1) * (1 + cb) + sb
    x = x + gb * _B_ref(h, B_w_gate, B_w_up, B_w_down)
    return x
```

```asm
; @launch grid=(256,1,1) block=(512,1,1) lds=83456
.amdgcn_target "amdgcn-amd-amdhsa--gfx950"
.text
.globl adaLN_cond__sliding_block_cached__swiglu_ffn__decode_kernel
.p2align 8
.type adaLN_cond__sliding_block_cached__swiglu_ffn__decode_kernel,@function
adaLN_cond__sliding_block_cached__swiglu_ffn__decode_kernel:
    s_cmp_ge_u32 s2, 256
    s_cbranch_scc1 L_end
    s_load_dwordx8 s[24:31], s[0:1], 64
    s_load_dwordx16 s[8:23], s[0:1], 0
    s_load_dwordx4 s[32:35], s[0:1], 96
    v_and_b32 v1, 63, v0
    v_lshrrev_b32 v40, 6, v0
    v_and_b32 v2, 15, v0
    v_readfirstlane_b32 s48, v40
    v_lshrrev_b32 v3, 4, v1
    s_and_b32 s50, s2, 7
    s_lshr_b32 s51, s2, 4
    s_lshl_b32 s49, s51, 3
    s_or_b32 s49, s49, s50
    s_mov_b32 s70, 200000
    v_lshrrev_b32 v40, 3, v1
    v_mul_u32_u24 v11, 24576, v40
    v_and_b32 v41, 7, v1
    v_lshl_add_u32 v11, v41, 4, v11
    v_lshlrev_b32 v42, 2, v40
    v_lshlrev_b32 v43, 3, v3
    v_lshlrev_b32 v14, 2, v1
    v_lshl_add_u32 v96, v41, 2, v3
    v_lshlrev_b32 v49, 1, v96
    v_lshlrev_b32 v96, 2, v96
    v_lshlrev_b32 v48, 5, v1
    s_and_b32 s64, s51, 7
    s_bitcmp1_b32 s2, 3
    s_cselect_b32 s64, s50, s64
    s_lshl_b32 s62, s64, 7
    s_lshl_b32 s63, s48, 4
    s_add_u32 s62, s62, s63
    s_mul_i32 s58, s62, 12288
    s_lshl_b32 s62, s62, 1
    s_mov_b32 s6, 12582912
    s_mov_b32 s7, 0x00020000
    s_mov_b32 s46, 2048
    s_mov_b32 s47, 0x00020000
    s_bitcmp1_b32 s2, 3
    s_cbranch_scc1 L_Q_pre
    s_and_b32 s65, s51, 8
    s_or_b32 s65, s65, s50
    s_lshl_b32 s60, s65, 8
    s_add_u32 s60, s60, s58
    v_mul_u32_u24 v97, 49152, v3
    v_lshl_add_u32 v97, v2, 4, v97
    v_add_u32 v97, s60, v97
    s_waitcnt lgkmcnt(0)
    s_mov_b32 s4, s28
    s_mov_b32 s5, s29
    s_mov_b32 s44, s26
    s_mov_b32 s45, s27
    buffer_load_dwordx2 v[46:47], v43, s[44:47], s62 offen
    buffer_load_dword v44, v42, s[44:47], s62 offen
    buffer_load_dwordx4 v[108:111], v97, s[4:7], 0 offen nt
    s_mov_b32 s69, 12288
    buffer_load_dwordx4 v[112:115], v97, s[4:7], s69 offen nt
    s_mov_b32 s68, 24576
    buffer_load_dwordx4 v[116:119], v97, s[4:7], s68 offen nt
    s_mov_b32 s69, 36864
    buffer_load_dwordx4 v[120:123], v97, s[4:7], s69 offen nt
    s_mov_b32 s14, s65
    s_and_b32 s66, s49, 3
    s_lshr_b32 s67, s49, 2
    s_lshl_b32 s62, s66, 24
    s_lshl_b32 s61, s67, 15
    s_add_u32 s62, s62, s61
    s_lshl_b32 s59, s48, 12
    s_add_u32 s62, s62, s59
    s_add_u32 s8, s62, 15728640
    s_mov_b32 s40, s10
    s_mov_b32 s41, s11
    s_mov_b32 s42, 67108864
    s_mov_b32 s43, 0x00020000
    s_mov_b32 s44, s12
    s_mov_b32 s45, s13
    s_mov_b32 s46, 67108864
    s_mov_b32 s47, 0x00020000
    v_xor_b32 v101, v2, v3
    v_lshlrev_b32 v101, 4, v101
    v_lshl_add_u32 v101, v3, 8, v101
    v_xor_b32 v102, 64, v101
    v_xor_b32 v103, 128, v101
    v_xor_b32 v104, 192, v101
    v_lshlrev_b32 v105, 1, v3
    v_xor_b32 v105, v2, v105
    v_lshlrev_b32 v105, 4, v105
    v_lshl_add_u32 v105, v3, 8, v105
    v_xor_b32 v106, 128, v105
    s_load_dword s56, s[34:35], 0
    s_mov_b32 s36, s34
    s_mov_b32 s37, s35
    s_mov_b32 s38, 2621440
    s_mov_b32 s39, 0x00020000
    s_getreg_b32 s60, hwreg(HW_REG_XCC_ID, 0, 4)
    s_cmp_eq_u32 s60, s50
    s_cselect_b32 s0, 0, 786432
    v_and_b32 v40, 1, v1
    v_mov_b32 v41, 0xffff
    v_lshlrev_b32 v40, 4, v40
    v_lshlrev_b32 v41, v40, v41
    v_bfe_u32 v40, v1, 1, 2
    v_cmp_eq_u32 vcc, 0, v40
    s_nop 1
    v_cndmask_b32 v4, 0, v41, vcc
    v_cmp_eq_u32 vcc, 1, v40
    s_nop 1
    v_cndmask_b32 v5, 0, v41, vcc
    v_cmp_eq_u32 vcc, 2, v40
    s_nop 1
    v_cndmask_b32 v6, 0, v41, vcc
    v_cmp_eq_u32 vcc, 3, v40
    s_nop 1
    v_cndmask_b32 v7, 0, v41, vcc
    v_mov_b32 v8, 0xff
    v_mov_b32 v77, 1.0
    v_add_u32 v107, 82432, v14
    s_lshl_b32 s60, s48, 9
    s_add_u32 s60, s60, 65536
    v_lshlrev_b32 v12, 5, v2
    v_lshl_add_u32 v12, v3, 4, v12
    v_add_u32 v12, s60, v12
    v_and_b32 v40, 7, v1
    v_lshlrev_b32 v13, 5, v40
    v_and_b32 v41, 1, v3
    v_lshl_add_u32 v13, v41, 4, v13
    v_lshrrev_b32 v41, 1, v3
    v_lshl_add_u32 v13, v41, 8, v13
    v_add_u32 v13, s60, v13
    s_and_b32 s3, s48, 1
    s_lshl_b32 s3, s3, 8
    s_lshr_b32 s32, s48, 1
    s_add_u32 s60, s3, 65536
    v_add_u32 v78, s60, v14
    s_mul_i32 s33, s64, 24576
    s_add_u32 s33, s33, 790528
    v_mul_u32_u24 v79, 24576, v3
    v_bfe_u32 v41, v1, 3, 1
    v_lshl_add_u32 v79, v41, 12, v79
    v_lshl_add_u32 v79, v40, 4, v79
    s_waitcnt lgkmcnt(0)
    s_xor_b32 s56, s56, 2641058359
    s_bfe_u32 s52, s56, 524288
    s_bfe_u32 s53, s56, 524296
    s_bfe_u32 s54, s56, 524304
    s_bfe_u32 s55, s56, 524312
    s_lshr_b32 s57, s56, 16
    v_mov_b32 v0, s56
    v_and_b32 v40, 3, v1
    v_lshlrev_b32 v40, 3, v40
    v_bfe_u32 v9, v0, v40, 8
    v_lshlrev_b32 v40, 3, v3
    v_bfe_u32 v10, v0, v40, 8
    s_waitcnt vmcnt(4)
    v_lshlrev_b32 v40, 16, v46
    v_and_b32 v41, 0xffff0000, v46
    v_mul_f32 v42, 0xbfb8aa3b, v40
    v_exp_f32 v42, v42
    s_nop 0
    v_add_f32 v42, 1.0, v42
    v_rcp_f32 v42, v42
    s_nop 0
    v_mul_f32 v40, v40, v42
    v_mul_f32 v43, 0xbfb8aa3b, v41
    v_exp_f32 v43, v43
    s_nop 0
    v_add_f32 v43, 1.0, v43
    v_rcp_f32 v43, v43
    s_nop 0
    v_mul_f32 v41, v41, v43
    v_cvt_pk_bf16_f32 v17, v40, v40
    v_cvt_pk_bf16_f32 v18, v41, v41
    v_lshlrev_b32 v40, 16, v47
    v_and_b32 v41, 0xffff0000, v47
    v_mul_f32 v42, 0xbfb8aa3b, v40
    v_exp_f32 v42, v42
    s_nop 0
    v_add_f32 v42, 1.0, v42
    v_rcp_f32 v42, v42
    s_nop 0
    v_mul_f32 v40, v40, v42
    v_mul_f32 v43, 0xbfb8aa3b, v41
    v_exp_f32 v43, v43
    s_nop 0
    v_add_f32 v43, 1.0, v43
    v_rcp_f32 v43, v43
    s_nop 0
    v_mul_f32 v41, v41, v43
    v_cvt_pk_bf16_f32 v19, v40, v40
    v_cvt_pk_bf16_f32 v20, v41, v41
    s_lshl_b32 s64, s65, 9
    s_add_u32 s33, s64, s33
    s_add_u32 s64, s33, s3
    s_sub_u32 s64, s64, 786432
    v_add_u32 v252, 6144, v97
    s_waitcnt vmcnt(0)
    s_mov_b32 m0, s59
    s_nop 0
    buffer_load_dwordx4 v101, s[40:43], s8 offen offset:0 nt lds
    buffer_load_dwordx4 v102, s[40:43], s8 offen offset:1024 nt lds
    v_and_b32 v24, v17, v4
    v_and_b32 v25, v17, v5
    v_and_b32 v26, v17, v6
    v_and_b32 v27, v17, v7
    v_and_b32 v28, v18, v4
    v_and_b32 v29, v18, v5
    v_and_b32 v30, v18, v6
    v_and_b32 v31, v18, v7
    v_mfma_f32_16x16x32_bf16 v[32:35], v[24:27], v[108:111], 0
    v_and_b32 v24, v19, v4
    v_and_b32 v25, v19, v5
    v_and_b32 v26, v19, v6
    v_and_b32 v27, v19, v7
    v_mfma_f32_16x16x32_bf16 v[32:35], v[28:31], v[112:115], v[32:35]
    v_and_b32 v28, v20, v4
    v_and_b32 v29, v20, v5
    v_and_b32 v30, v20, v6
    v_and_b32 v31, v20, v7
    v_mfma_f32_16x16x32_bf16 v[32:35], v[24:27], v[116:119], v[32:35]
    s_nop 0
    v_mfma_f32_16x16x32_bf16 v[32:35], v[28:31], v[120:123], v[32:35]
    s_mov_b32 exec_hi, 0
    s_nop 6
    ds_write_b128 v12, v[32:35] offset:0
    s_mov_b32 exec_hi, -1
    s_waitcnt lgkmcnt(0)
    s_barrier
    s_cmp_eq_u32 s32, 0
    s_cbranch_scc0 L_fa_1
    ds_read2st64_b32 v[80:81], v78 offset0:0 offset1:2
    ds_read2st64_b32 v[82:83], v78 offset0:4 offset1:6
    ds_read2st64_b32 v[84:85], v78 offset0:8 offset1:10
    ds_read2st64_b32 v[86:87], v78 offset0:12 offset1:14
    s_waitcnt lgkmcnt(0)
    v_add_f32 v80, v80, v81
    v_add_f32 v82, v82, v83
    v_add_f32 v84, v84, v85
    v_add_f32 v86, v86, v87
    v_add_f32 v80, v80, v82
    v_add_f32 v84, v84, v86
    v_add_f32 v80, v80, v84
    v_bfi_b32 v80, v8, v9, v80
    s_cmp_eq_u32 s0, 0
    s_cbranch_scc0 L_sn_2
    buffer_store_dword v80, v14, s[36:39], s64 offen offset:0
L_sn_2:
    s_add_u32 s1, s64, 786432
    buffer_store_dword v80, v14, s[36:39], s1 offen offset:0 sc1
    s_cmp_eq_u32 s0, 0
    s_cbranch_scc1 L_sf_3
    buffer_store_dword v80, v14, s[36:39], s64 offen offset:0 sc1
L_sf_3:
L_fa_1:
    s_barrier
    buffer_load_dwordx4 v103, s[40:43], s8 offen offset:2048 nt lds
    buffer_load_dwordx4 v104, s[40:43], s8 offen offset:3072 nt lds
    s_add_u32 m0, s59, 32768
    s_nop 0
    buffer_load_dwordx4 v105, s[44:47], s8 offen offset:0 nt lds
    buffer_load_dwordx4 v105, s[44:47], s8 offen offset:1024 nt lds
    buffer_load_dwordx4 v106, s[44:47], s8 offen offset:2048 nt lds
    buffer_load_dwordx4 v106, s[44:47], s8 offen offset:3072 nt lds
    v_lshlrev_b32 v40, 16, v44
    v_and_b32 v41, 0xffff0000, v44
    v_mul_f32 v42, 0xbfb8aa3b, v40
    v_exp_f32 v42, v42
    s_nop 0
    v_add_f32 v42, 1.0, v42
    v_rcp_f32 v42, v42
    s_nop 0
    v_mul_f32 v40, v40, v42
    v_mul_f32 v43, 0xbfb8aa3b, v41
    v_exp_f32 v43, v43
    s_nop 0
    v_add_f32 v43, 1.0, v43
    v_rcp_f32 v43, v43
    s_nop 0
    v_mul_f32 v41, v41, v43
    v_cvt_pk_bf16_f32 v15, v40, v40
    v_cvt_pk_bf16_f32 v16, v41, v41
    s_max_u32 s61, s48, 1
    s_sub_u32 s61, s61, 1
    s_lshl_b32 s19, s51, 6
    s_mul_i32 s18, s51, 3584
    s_mul_i32 s62, s50, 57344
    s_add_u32 s18, s18, s62
    s_add_u32 s18, s18, 331776
    s_cmp_ge_u32 s61, 3
    s_cselect_b32 s69, 1, 0
    s_cselect_b32 s62, 3, 0
    s_sub_u32 s62, s61, s62
    s_lshl_b32 s62, s62, 7
    s_and_b32 s60, s50, 1
    s_lshl_b32 s60, s60, 6
    s_add_u32 s62, s62, s60
    s_cmp_eq_u32 s62, 448
    s_cselect_b32 s62, 0, s62
    s_add_u32 s63, s62, 64
    s_cmp_eq_u32 s61, 6
    s_cselect_b32 s63, s62, s63
    s_cselect_b32 s68, 0, s69
    s_mul_i32 s60, s68, 448
    s_add_u32 s60, s60, s62
    s_mul_i32 s61, s69, 448
    s_add_u32 s61, s61, s63
    v_mov_b32 v44, s60
    v_mov_b32 v45, s61
    s_mul_i32 s60, s19, 7168
    s_mul_i32 s61, s50, 896
    s_add_u32 s60, s60, s61
    s_lshl_b32 s62, s62, 1
    s_lshl_b32 s63, s63, 1
    s_add_u32 s62, s62, s60
    s_add_u32 s63, s63, s60
    s_cmp_eq_u32 s68, 1
    s_cselect_b32 s60, s22, s20
    s_cselect_b32 s61, s23, s21
    s_add_u32 s60, s60, s62
    s_addc_u32 s61, s61, 0
    v_mov_b32 v40, s60
    v_mov_b32 v41, s61
    s_cmp_eq_u32 s69, 1
    s_cselect_b32 s60, s22, s20
    s_cselect_b32 s61, s23, s21
    s_add_u32 s60, s60, s63
    s_addc_u32 s61, s61, 0
    v_mov_b32 v42, s60
    v_mov_b32 v43, s61
    v_cmp_lt_u32 vcc, 7, v2
    s_nop 1
    v_cndmask_b32 v98, v40, v42, vcc
    v_cndmask_b32 v99, v41, v43, vcc
    v_cndmask_b32 v100, v44, v45, vcc
    v_mul_u32_u24 v40, 7168, v3
    v_and_b32 v41, 7, v1
    v_lshl_add_u32 v40, v41, 4, v40
    v_lshl_add_u32 v100, v41, 3, v100
    v_lshl_add_u32 v100, v3, 2, v100
    v_lshlrev_b32 v100, 2, v100
    v_add_co_u32 v98, vcc, v98, v40
    s_nop 1
    v_addc_co_u32 v99, vcc, 0, v99, vcc
    s_lshl_b32 s60, s14, 7
    s_add_u32 s60, s60, s58
    s_add_u32 s60, s60, 10240
    v_add_u32 v253, s60, v11
    v_xor_b32 v70, v2, v3
    v_lshlrev_b32 v70, 4, v70
    v_lshl_add_u32 v70, v2, 8, v70
    s_lshl_b32 s61, s48, 12
    v_add_u32 v70, s61, v70
    v_bfe_u32 v40, v1, 2, 2
    v_and_b32 v41, 1, v3
    v_lshl_or_b32 v41, v41, 2, v40
    v_lshlrev_b32 v41, 1, v41
    v_bfe_u32 v42, v1, 1, 1
    s_lshl_b32 s61, s48, 1
    v_or_b32 v42, s61, v42
    v_xor_b32 v42, v42, v41
    v_lshl_add_u32 v40, v3, 3, v40
    v_lshlrev_b32 v71, 8, v40
    v_lshl_add_u32 v71, v42, 4, v71
    v_and_b32 v40, 1, v1
    v_lshl_add_u32 v71, v40, 3, v71
    v_add_u32 v71, 32768, v71
    v_and_b32 v40, 7, v1
    v_mul_u32_u24 v72, 272, v40
    v_lshl_add_u32 v75, v3, 3, v72
    v_lshl_add_u32 v72, v3, 4, v72
    v_add_u32 v72, 77824, v72
    s_lshl_b32 s61, s48, 5
    s_add_u32 s61, s61, 80000
    v_add_u32 v75, s61, v75
    v_lshlrev_b32 v66, 5, v40
    v_add_u32 v66, 82176, v66
    s_lshl_b32 s61, s48, 2
    v_add_u32 v67, s61, v66
    v_lshlrev_b32 v73, 14, v3
    v_lshl_add_u32 v73, v2, 4, v73
    v_lshl_add_u32 v74, v2, 2, v3
    v_lshlrev_b32 v74, 1, v74
    s_mul_i32 s61, s48, 272
    s_add_u32 s61, s61, 77824
    v_add_u32 v74, s61, v74
    v_lshlrev_b32 v68, 7, v3
    v_lshl_add_u32 v68, v2, 4, v68
    v_lshlrev_b32 v69, 3, v1
    s_lshl_b32 s62, s66, 3
    s_add_u32 s62, s62, s48
    s_lshl_b32 s63, s62, 5
    s_add_u32 s63, s63, s67
    s_lshl_b32 s62, s62, 9
    s_add_u32 s62, s62, 1576960
    s_lshl_b32 s66, s63, 9
    s_add_u32 s66, s66, 1708032
    s_lshl_b32 s67, s63, 6
    s_add_u32 s67, s67, 1708032
    s_add_u32 s63, s62, 65536
    v_xor_b32 v60, 64, v70
    v_xor_b32 v61, 128, v70
    v_xor_b32 v62, 192, v70
    v_mov_b32 v24, 0x3f803f80
    v_mov_b32 v25, 0x3f803f80
    v_mov_b32 v26, 0x3f803f80
    v_mov_b32 v27, 0x3f803f80
    s_mov_b32 s61, 1069066811
    s_cmp_eq_u32 s48, 0
    s_cbranch_scc0 L_gated_5
    s_lshl_b32 s68, s2, 7
    s_add_u32 s68, s68, 2428928
L_gate_4:
    s_buffer_load_dword s69, s[36:39], s68 glc
    s_waitcnt lgkmcnt(0)
    s_cmp_eq_u32 s69, s56
    s_cbranch_scc1 L_gated_5
    s_sub_u32 s70, s70, 1
    s_cbranch_scc0 L_gate_4
    s_mov_b32 s70, 0
L_gated_5:
    s_waitcnt lgkmcnt(0)
    s_barrier
    buffer_load_dwordx4 v[40:43], v73, s[36:39], s62 offen sc1
    buffer_load_dwordx4 v[44:47], v73, s[36:39], s62 offen offset:256 sc1
    buffer_load_dwordx4 v[48:51], v73, s[36:39], s63 offen sc1
    buffer_load_dwordx4 v[52:55], v73, s[36:39], s63 offen offset:256 sc1
    s_waitcnt vmcnt(0)
    ds_read_b128 v[204:207], v70
    ds_read_b128 v[208:211], v60
    ds_read_b128 v[212:215], v61
    ds_read_b128 v[216:219], v62
L_h2_w_6:
    v_xor_b32 v40, s52, v40
    v_xor_b32 v41, s53, v41
    v_xor_b32 v42, s54, v42
    v_xor_b32 v43, s55, v43
    v_xor_b32 v44, s52, v44
    v_xor_b32 v45, s53, v45
    v_xor_b32 v46, s54, v46
    v_xor_b32 v47, s55, v47
    v_xor_b32 v48, s52, v48
    v_xor_b32 v49, s53, v49
    v_xor_b32 v50, s54, v50
    v_xor_b32 v51, s55, v51
    v_xor_b32 v52, s52, v52
    v_xor_b32 v53, s53, v53
    v_xor_b32 v54, s54, v54
    v_xor_b32 v55, s55, v55
    v_or_b32 v21, v40, v41
    v_or3_b32 v21, v21, v42, v43
    v_or3_b32 v21, v21, v44, v45
    v_or3_b32 v21, v21, v46, v47
    v_or3_b32 v21, v21, v48, v49
    v_or3_b32 v21, v21, v50, v51
    v_or3_b32 v21, v21, v52, v53
    v_or3_b32 v21, v21, v54, v55
    v_and_b32 v21, 0xff, v21
    v_cmp_ne_u32 vcc, 0, v21
    s_cbranch_vccz L_h2_d_7
    s_mov_b64 exec, vcc
    buffer_load_dwordx4 v[40:43], v73, s[36:39], s62 offen sc1
    buffer_load_dwordx4 v[44:47], v73, s[36:39], s62 offen offset:256 sc1
    buffer_load_dwordx4 v[48:51], v73, s[36:39], s63 offen sc1
    buffer_load_dwordx4 v[52:55], v73, s[36:39], s63 offen offset:256 sc1
    s_sub_u32 s70, s70, 1
    s_waitcnt vmcnt(0)
    s_cbranch_scc0 L_h2_w_6
    s_mov_b32 s70, 0
L_h2_d_7:
    s_mov_b64 exec, -1
    v_add_f32 v40, v40, v48
    v_add_f32 v41, v41, v49
    v_add_f32 v42, v42, v50
    v_add_f32 v43, v43, v51
    v_add_f32 v44, v44, v52
    v_add_f32 v45, v45, v53
    v_add_f32 v46, v46, v54
    v_add_f32 v47, v47, v55
    v_permlane32_swap_b32 v40, v42
    v_permlane32_swap_b32 v41, v43
    v_permlane32_swap_b32 v44, v46
    v_permlane32_swap_b32 v45, v47
    v_add_f32 v40, v40, v42
    v_add_f32 v41, v41, v43
    v_add_f32 v44, v44, v46
    v_add_f32 v45, v45, v47
    v_permlane16_swap_b32 v40, v41
    s_nop 0
    v_permlane16_swap_b32 v44, v45
    v_add_f32 v40, v40, v41
    v_add_f32 v44, v44, v45
    v_cvt_pk_bf16_f32 v40, v40, v44
    ds_write_b16 v74, v40
    ds_write_b16_d16_hi v74, v40 offset:128
    s_waitcnt lgkmcnt(0)
    s_barrier
    ds_read_b128 v[236:239], v72 offset:0
    ds_read_b128 v[240:243], v72 offset:64
    ds_read_b128 v[244:247], v72 offset:128
    ds_read_b128 v[248:251], v72 offset:192
    ds_read_b64_tr_b16 v[220:221], v71 offset:0
    ds_read_b64_tr_b16 v[222:223], v71 offset:1024
    ds_read_b64_tr_b16 v[224:225], v71 offset:8192
    ds_read_b64_tr_b16 v[226:227], v71 offset:9216
    ds_read_b64_tr_b16 v[228:229], v71 offset:16384
    ds_read_b64_tr_b16 v[230:231], v71 offset:17408
    ds_read_b64_tr_b16 v[232:233], v71 offset:24576
    ds_read_b64_tr_b16 v[234:235], v71 offset:25600
    buffer_load_dwordx4 v[124:127], v252, s[4:7], 0 offen nt
    s_mov_b32 s69, 12288
    buffer_load_dwordx4 v[128:131], v252, s[4:7], s69 offen nt
    s_mov_b32 s68, 24576
    buffer_load_dwordx4 v[132:135], v252, s[4:7], s68 offen nt
    s_mov_b32 s69, 36864
    buffer_load_dwordx4 v[136:139], v252, s[4:7], s69 offen nt
    s_waitcnt lgkmcnt(11)
    v_mfma_f32_16x16x32_bf16 v[32:35], v[204:207], v[236:239], 0
    s_waitcnt lgkmcnt(10)
    v_mfma_f32_16x16x32_bf16 v[32:35], v[208:211], v[240:243], v[32:35]
    s_waitcnt lgkmcnt(9)
    v_mfma_f32_16x16x32_bf16 v[32:35], v[212:215], v[244:247], v[32:35]
    s_waitcnt lgkmcnt(8)
    v_mfma_f32_16x16x32_bf16 v[32:35], v[216:219], v[248:251], v[32:35]
    s_nop 7
    v_cvt_pk_bf16_f32 v40, v32, v33
    v_cvt_pk_bf16_f32 v42, v34, v35
    v_and_b32 v41, 0xffff0000, v40
    v_lshlrev_b32 v40, 16, v40
    v_and_b32 v43, 0xffff0000, v42
    v_lshlrev_b32 v42, 16, v42
    v_mul_f32 v40, 1035273459, v40
    v_mul_f32 v41, 1035273459, v41
    v_mul_f32 v42, 1035273459, v42
    v_mul_f32 v43, 1035273459, v43
    v_cvt_pk_bf16_f32 v40, v40, v41
    v_cvt_pk_bf16_f32 v42, v42, v43
    v_and_b32 v41, 0xffff0000, v40
    v_lshlrev_b32 v40, 16, v40
    v_and_b32 v43, 0xffff0000, v42
    v_lshlrev_b32 v42, 16, v42
    v_max3_f32 v44, v40, v41, v42
    v_max_f32 v44, v44, v43
    v_mov_b32 v45, v44
    s_nop 1
    v_permlane16_swap_b32 v44, v45
    v_max_f32 v44, v44, v45
    v_mov_b32 v45, v44
    s_nop 1
    v_permlane32_swap_b32 v44, v45
    v_max_f32 v44, v44, v45
    s_mov_b64 exec, 0xff
    ds_write_b32 v67, v44
    s_mov_b64 exec, -1
    s_waitcnt lgkmcnt(0)
    s_barrier
    ds_read_b128 v[52:55], v66
    ds_read_b128 v[56:59], v66 offset:16
    s_waitcnt lgkmcnt(0)
    v_max3_f32 v44, v52, v53, v54
    v_max3_f32 v45, v55, v56, v57
    v_max3_f32 v44, v44, v58, v59
    v_max_f32 v44, v44, v45
    v_sub_f32 v40, v40, v44
    v_sub_f32 v41, v41, v44
    v_sub_f32 v42, v42, v44
    v_sub_f32 v43, v43, v44
    v_mul_f32 v40, s61, v40
    v_mul_f32 v41, s61, v41
    v_mul_f32 v42, s61, v42
    v_mul_f32 v43, s61, v43
    v_exp_f32 v40, v40
    v_exp_f32 v41, v41
    v_exp_f32 v42, v42
    v_exp_f32 v43, v43
    v_cvt_pk_bf16_f32 v46, v40, v41
    v_cvt_pk_bf16_f32 v47, v42, v43
    s_mov_b32 exec_lo, 0x00ff00ff
    s_mov_b32 exec_hi, 0x00ff00ff
    ds_write_b64 v75, v[46:47]
    s_mov_b64 exec, -1
    v_mul_f32 v44, s61, v44
    s_mov_b32 s62, 0x07060503
    s_mov_b32 s63, 0x07060502
    s_mov_b32 s64, 0x07060501
    s_waitcnt lgkmcnt(0)
    s_barrier
    ds_read_b128 v[236:239], v72 offset:2176
    ds_read_b128 v[240:243], v72 offset:2240
    ds_read_b128 v[244:247], v72 offset:2304
    ds_read_b128 v[248:251], v72 offset:2368
    s_waitcnt lgkmcnt(3)
    v_mfma_f32_16x16x32_bf16 v[36:39], v[24:27], v[236:239], 0
    v_mfma_f32_16x16x32_bf16 v[32:35], v[220:223], v[236:239], 0
    s_waitcnt lgkmcnt(2)
    v_mfma_f32_16x16x32_bf16 v[36:39], v[24:27], v[240:243], v[36:39]
    v_mfma_f32_16x16x32_bf16 v[32:35], v[224:227], v[240:243], v[32:35]
    s_waitcnt lgkmcnt(1)
    v_mfma_f32_16x16x32_bf16 v[36:39], v[24:27], v[244:247], v[36:39]
    v_mfma_f32_16x16x32_bf16 v[32:35], v[228:231], v[244:247], v[32:35]
    s_waitcnt lgkmcnt(0)
    v_mfma_f32_16x16x32_bf16 v[36:39], v[24:27], v[248:251], v[36:39]
    v_mfma_f32_16x16x32_bf16 v[32:35], v[232:235], v[248:251], v[32:35]
    s_nop 6
    v_log_f32 v45, v36
    v_rcp_f32 v46, v36
    v_add_f32 v44, v44, v45
    v_mul_f32 v32, v32, v46
    v_mul_f32 v33, v33, v46
    v_mul_f32 v34, v34, v46
    v_mul_f32 v35, v35, v46
    v_add_u32 v44, 0x80, v44
    v_bfi_b32 v32, v8, v9, v32
    v_perm_b32 v33, v33, v44, s62
    v_perm_b32 v34, v34, v44, s63
    v_perm_b32 v35, v35, v44, s64
    s_mov_b32 exec_lo, 0x00ff00ff
    s_mov_b32 exec_hi, 0x00ff00ff
    buffer_store_dwordx4 v[32:35], v68, s[36:39], s66 offen sc1
    s_mov_b64 exec, -1
    s_cmp_eq_u32 s48, 0
    s_cbranch_scc0 L_sg_8
    s_xor_b32 s68, s2, 8
    s_lshl_b32 s68, s68, 7
    s_add_u32 s68, s68, 2461696
    s_mov_b64 exec, 1
    buffer_store_dword v0, v14, s[36:39], s68 offen sc1
    s_mov_b64 exec, -1
L_sg_8:
    s_barrier
    s_cmp_eq_u32 s48, 0
    s_cbranch_scc1 L_nw_9
    global_load_dwordx4 v[140:143], v[98:99], off nt
    v_add_co_u32 v98, vcc, 28672, v98
    s_nop 1
    v_addc_co_u32 v99, vcc, 0, v99, vcc
    global_load_dwordx4 v[144:147], v[98:99], off nt
    v_add_co_u32 v98, vcc, 28672, v98
    s_nop 1
    v_addc_co_u32 v99, vcc, 0, v99, vcc
    global_load_dwordx4 v[148:151], v[98:99], off nt
    v_add_co_u32 v98, vcc, 28672, v98
    s_nop 1
    v_addc_co_u32 v99, vcc, 0, v99, vcc
    global_load_dwordx4 v[152:155], v[98:99], off nt
    s_waitcnt vmcnt(4)
    s_branch L_nj_10
L_nw_9:
    s_waitcnt vmcnt(0)
L_nj_10:
    v_and_b32 v24, v17, v4
    v_and_b32 v25, v17, v5
    v_and_b32 v26, v17, v6
    v_and_b32 v27, v17, v7
    v_and_b32 v28, v18, v4
    v_and_b32 v29, v18, v5
    v_and_b32 v30, v18, v6
    v_and_b32 v31, v18, v7
    v_mfma_f32_16x16x32_bf16 v[32:35], v[24:27], v[124:127], 0
    v_and_b32 v24, v19, v4
    v_and_b32 v25, v19, v5
    v_and_b32 v26, v19, v6
    v_and_b32 v27, v19, v7
    v_mfma_f32_16x16x32_bf16 v[32:35], v[28:31], v[128:131], v[32:35]
    v_and_b32 v28, v20, v4
    v_and_b32 v29, v20, v5
    v_and_b32 v30, v20, v6
    v_and_b32 v31, v20, v7
    v_mfma_f32_16x16x32_bf16 v[32:35], v[24:27], v[132:135], v[32:35]
    s_nop 0
    v_mfma_f32_16x16x32_bf16 v[32:35], v[28:31], v[136:139], v[32:35]
    s_mov_b32 exec_hi, 0
    s_nop 6
    ds_write_b128 v12, v[32:35] offset:8192
    s_mov_b32 exec_hi, -1
    s_waitcnt lgkmcnt(0)
    s_barrier
    s_add_u32 s64, s33, 12288
    s_add_u32 s65, s3, s64
    s_cmp_eq_u32 s32, 1
    s_cbranch_scc0 L_fa_11
    ds_read2st64_b32 v[80:81], v78 offset0:32 offset1:34
    ds_read2st64_b32 v[82:83], v78 offset0:36 offset1:38
    ds_read2st64_b32 v[84:85], v78 offset0:40 offset1:42
    ds_read2st64_b32 v[86:87], v78 offset0:44 offset1:46
    s_waitcnt lgkmcnt(0)
    v_add_f32 v80, v80, v81
    v_add_f32 v82, v82, v83
    v_add_f32 v84, v84, v85
    v_add_f32 v86, v86, v87
    v_add_f32 v80, v80, v82
    v_add_f32 v84, v84, v86
    v_add_f32 v80, v80, v84
    v_bfi_b32 v80, v8, v9, v80
    buffer_store_dword v80, v14, s[36:39], s65 offen sc1
L_fa_11:
    s_barrier
    s_cmp_eq_u32 s48, 0
    s_cbranch_scc1 L_nw_12
    v_add_co_u32 v98, vcc, 28672, v98
    s_nop 1
    v_addc_co_u32 v99, vcc, 0, v99, vcc
    global_load_dwordx4 v[156:159], v[98:99], off nt
    v_add_co_u32 v98, vcc, 28672, v98
    s_nop 1
    v_addc_co_u32 v99, vcc, 0, v99, vcc
    global_load_dwordx4 v[160:163], v[98:99], off nt
    v_add_co_u32 v98, vcc, 28672, v98
    s_nop 1
    v_addc_co_u32 v99, vcc, 0, v99, vcc
    global_load_dwordx4 v[164:167], v[98:99], off nt
    v_add_co_u32 v98, vcc, 28672, v98
    s_nop 1
    v_addc_co_u32 v99, vcc, 0, v99, vcc
    global_load_dwordx4 v[168:171], v[98:99], off nt
    v_add_co_u32 v98, vcc, 28672, v98
    s_nop 1
    v_addc_co_u32 v99, vcc, 0, v99, vcc
    global_load_dwordx4 v[172:175], v[98:99], off nt
    v_add_co_u32 v98, vcc, 28672, v98
    s_nop 1
    v_addc_co_u32 v99, vcc, 0, v99, vcc
    global_load_dwordx4 v[176:179], v[98:99], off nt
    v_add_co_u32 v98, vcc, 28672, v98
    s_nop 1
    v_addc_co_u32 v99, vcc, 0, v99, vcc
    global_load_dwordx4 v[180:183], v[98:99], off nt
    v_add_co_u32 v98, vcc, 28672, v98
    s_nop 1
    v_addc_co_u32 v99, vcc, 0, v99, vcc
    global_load_dwordx4 v[184:187], v[98:99], off nt
    v_add_co_u32 v98, vcc, 28672, v98
    s_nop 1
    v_addc_co_u32 v99, vcc, 0, v99, vcc
    global_load_dwordx4 v[188:191], v[98:99], off nt
    v_add_co_u32 v98, vcc, 28672, v98
    s_nop 1
    v_addc_co_u32 v99, vcc, 0, v99, vcc
    global_load_dwordx4 v[192:195], v[98:99], off nt
    v_add_co_u32 v98, vcc, 28672, v98
    s_nop 1
    v_addc_co_u32 v99, vcc, 0, v99, vcc
    global_load_dwordx4 v[196:199], v[98:99], off nt
    v_add_co_u32 v98, vcc, 28672, v98
    s_nop 1
    v_addc_co_u32 v99, vcc, 0, v99, vcc
    global_load_dwordx4 v[200:203], v[98:99], off nt
    s_waitcnt vmcnt(0)
    s_branch L_nj_13
L_nw_12:
    v_and_b32 v67, 31, v1
    v_lshlrev_b32 v67, 8, v67
    v_bfe_u32 v66, v1, 3, 1
    v_lshl_add_u32 v66, v66, 8, v96
    s_lshl_b32 s63, s50, 13
    s_add_u32 s63, s63, 200704
    s_add_u32 s63, s63, s0
    s_lshl_b32 s62, s19, 3
    s_add_u32 s62, s62, s63
    s_add_u32 s60, s62, 65536
    buffer_load_dword v254, v66, s[36:39], s60 offen sc1
    buffer_load_dword v255, v66, s[36:39], s60 offen offset:128 sc1
    buffer_load_dwordx4 v[56:59], v67, s[36:39], s63 offen offset:128 sc1
    buffer_load_dword v60, v66, s[36:39], s62 offen sc1
    s_waitcnt vmcnt(0)
L_sbcb_w_14:
    v_xor_b32 v254, v10, v254
    v_xor_b32 v255, v10, v255
    v_or_b32 v21, v254, v255
    v_and_b32 v21, 0xff, v21
    v_cmp_ne_u32 vcc, 0, v21
    s_cbranch_vccz L_sbcb_d_15
    s_sleep 4
    buffer_load_dword v254, v66, s[36:39], s60 offen sc1
    buffer_load_dword v255, v66, s[36:39], s60 offen offset:128 sc1
    buffer_load_dwordx4 v[56:59], v67, s[36:39], s63 offen offset:128 sc1
    buffer_load_dword v60, v66, s[36:39], s62 offen sc1
    s_sub_u32 s70, s70, 1
    s_waitcnt vmcnt(0)
    s_cbranch_scc0 L_sbcb_w_14
    s_mov_b32 s70, 0
L_sbcb_d_15:
L_h5a_w_16:
    v_xor_b32 v60, v10, v60
    v_and_b32 v21, 0xff, v60
    v_bitop3_b32 v21, v21, v57, s56 bitop3:0xf6
    v_bitop3_b32 v21, v21, v59, s56 bitop3:0xf6
    v_cmp_ne_u32 vcc, 0, v21
    s_cbranch_vccz L_h5a_d_17
    s_sleep 2
    buffer_load_dwordx4 v[56:59], v67, s[36:39], s63 offen offset:128 sc1
    buffer_load_dword v60, v66, s[36:39], s62 offen sc1
    s_sub_u32 s70, s70, 1
    s_waitcnt vmcnt(0)
    s_cbranch_scc0 L_h5a_w_16
    s_mov_b32 s70, 0
L_h5a_d_17:
    v_add_f32_dpp v56, v56, v56 quad_perm:[1,0,3,2] row_mask:0xf bank_mask:0xf
    v_add_f32_dpp v58, v58, v58 quad_perm:[1,0,3,2] row_mask:0xf bank_mask:0xf
    s_nop 0
    v_add_f32_dpp v56, v56, v56 quad_perm:[2,3,0,1] row_mask:0xf bank_mask:0xf
    v_add_f32_dpp v58, v58, v58 quad_perm:[2,3,0,1] row_mask:0xf bank_mask:0xf
    s_nop 0
    v_add_f32_dpp v56, v56, v56 row_half_mirror row_mask:0xf bank_mask:0xf
    v_add_f32_dpp v58, v58, v58 row_half_mirror row_mask:0xf bank_mask:0xf
    s_nop 0
    v_add_f32_dpp v56, v56, v56 row_mirror row_mask:0xf bank_mask:0xf
    v_add_f32_dpp v58, v58, v58 row_mirror row_mask:0xf bank_mask:0xf
    v_mov_b32 v50, v56
    v_mov_b32 v51, v58
    s_nop 0
    v_permlane16_swap_b32 v56, v50
    v_permlane16_swap_b32 v58, v51
    v_add_f32 v56, v56, v50
    v_add_f32 v58, v58, v51
    v_mov_b32 v50, v56
    v_mov_b32 v51, v58
    s_nop 0
    v_permlane32_swap_b32 v56, v50
    v_permlane32_swap_b32 v58, v51
    v_add_f32 v56, v56, v50
    v_add_f32 v58, v58, v51
    v_mul_f32 v52, 0x39800000, v56
    v_mul_f32 v53, 0x39800000, v58
    v_fma_f32 v53, -v52, v52, v53
    v_max_f32 v53, 0, v53
    v_cvt_pk_bf16_f32 v53, v53, v53
    v_and_b32 v53, 0xffff0000, v53
    v_cvt_pk_bf16_f32 v52, v52, v52
    v_and_b32 v52, 0xffff0000, v52
    v_add_f32 v53, 925353388, v53
    v_cvt_pk_bf16_f32 v53, v53, v53
    v_and_b32 v53, 0xffff0000, v53
    v_sqrt_f32 v53, v53
    s_nop 0
    v_cvt_pk_bf16_f32 v53, v53, v53
    v_and_b32 v53, 0xffff0000, v53
    v_rcp_f32 v53, v53
    v_sub_f32 v50, v60, v52
    v_cvt_pk_bf16_f32 v50, v50, v50
    v_and_b32 v50, 0xffff0000, v50
    v_mul_f32 v50, v50, v53
    v_cvt_pk_bf16_f32 v23, v50, v50
    v_and_b32 v23, 0xffff0000, v23
    v_mul_f32 v41, v23, v255
    v_cvt_pk_bf16_f32 v41, v41, v41
    v_and_b32 v41, 0xffff0000, v41
    v_add_f32 v41, v41, v254
    v_cvt_pk_bf16_f32 v22, v41, v41
    ds_write_b32 v107, v22
L_nj_13:
    s_waitcnt lgkmcnt(0)
    s_barrier
    ds_read_b32 v22, v107
    buffer_load_dwordx4 v[204:207], v253, s[4:7], 0 offen nt
    s_mov_b32 s69, 12288
    buffer_load_dwordx4 v[208:211], v253, s[4:7], s69 offen nt
    s_waitcnt lgkmcnt(0)
    s_cmp_eq_u32 s48, 0
    s_cbranch_scc1 L_nw_18
    v_and_b32_dpp v24, v22, v4 row_newbcast:0 row_mask:0xf bank_mask:0xf
    v_and_b32_dpp v25, v22, v5 row_newbcast:0 row_mask:0xf bank_mask:0xf
    v_and_b32_dpp v26, v22, v6 row_newbcast:0 row_mask:0xf bank_mask:0xf
    v_and_b32_dpp v27, v22, v7 row_newbcast:0 row_mask:0xf bank_mask:0xf
    v_and_b32_dpp v28, v22, v4 row_newbcast:1 row_mask:0xf bank_mask:0xf
    v_and_b32_dpp v29, v22, v5 row_newbcast:1 row_mask:0xf bank_mask:0xf
    v_and_b32_dpp v30, v22, v6 row_newbcast:1 row_mask:0xf bank_mask:0xf
    v_and_b32_dpp v31, v22, v7 row_newbcast:1 row_mask:0xf bank_mask:0xf
    v_mfma_f32_16x16x32_bf16 v[32:35], v[24:27], v[140:143], 0
    v_and_b32_dpp v24, v22, v4 row_newbcast:2 row_mask:0xf bank_mask:0xf
    v_and_b32_dpp v25, v22, v5 row_newbcast:2 row_mask:0xf bank_mask:0xf
    v_and_b32_dpp v26, v22, v6 row_newbcast:2 row_mask:0xf bank_mask:0xf
    v_and_b32_dpp v27, v22, v7 row_newbcast:2 row_mask:0xf bank_mask:0xf
    v_mfma_f32_16x16x32_bf16 v[32:35], v[28:31], v[144:147], v[32:35]
    v_and_b32_dpp v28, v22, v4 row_newbcast:3 row_mask:0xf bank_mask:0xf
    v_and_b32_dpp v29, v22, v5 row_newbcast:3 row_mask:0xf bank_mask:0xf
    v_and_b32_dpp v30, v22, v6 row_newbcast:3 row_mask:0xf bank_mask:0xf
    v_and_b32_dpp v31, v22, v7 row_newbcast:3 row_mask:0xf bank_mask:0xf
    v_mfma_f32_16x16x32_bf16 v[32:35], v[24:27], v[148:151], v[32:35]
    v_and_b32_dpp v24, v22, v4 row_newbcast:4 row_mask:0xf bank_mask:0xf
    v_and_b32_dpp v25, v22, v5 row_newbcast:4 row_mask:0xf bank_mask:0xf
    v_and_b32_dpp v26, v22, v6 row_newbcast:4 row_mask:0xf bank_mask:0xf
    v_and_b32_dpp v27, v22, v7 row_newbcast:4 row_mask:0xf bank_mask:0xf
    v_mfma_f32_16x16x32_bf16 v[32:35], v[28:31], v[152:155], v[32:35]
    v_and_b32_dpp v28, v22, v4 row_newbcast:5 row_mask:0xf bank_mask:0xf
    v_and_b32_dpp v29, v22, v5 row_newbcast:5 row_mask:0xf bank_mask:0xf
    v_and_b32_dpp v30, v22, v6 row_newbcast:5 row_mask:0xf bank_mask:0xf
    v_and_b32_dpp v31, v22, v7 row_newbcast:5 row_mask:0xf bank_mask:0xf
    v_mfma_f32_16x16x32_bf16 v[32:35], v[24:27], v[156:159], v[32:35]
    v_and_b32_dpp v24, v22, v4 row_newbcast:6 row_mask:0xf bank_mask:0xf
    v_and_b32_dpp v25, v22, v5 row_newbcast:6 row_mask:0xf bank_mask:0xf
    v_and_b32_dpp v26, v22, v6 row_newbcast:6 row_mask:0xf bank_mask:0xf
    v_and_b32_dpp v27, v22, v7 row_newbcast:6 row_mask:0xf bank_mask:0xf
    v_mfma_f32_16x16x32_bf16 v[32:35], v[28:31], v[160:163], v[32:35]
    v_and_b32_dpp v28, v22, v4 row_newbcast:7 row_mask:0xf bank_mask:0xf
    v_and_b32_dpp v29, v22, v5 row_newbcast:7 row_mask:0xf bank_mask:0xf
    v_and_b32_dpp v30, v22, v6 row_newbcast:7 row_mask:0xf bank_mask:0xf
    v_and_b32_dpp v31, v22, v7 row_newbcast:7 row_mask:0xf bank_mask:0xf
    v_mfma_f32_16x16x32_bf16 v[32:35], v[24:27], v[164:167], v[32:35]
    v_and_b32_dpp v24, v22, v4 row_newbcast:8 row_mask:0xf bank_mask:0xf
    v_and_b32_dpp v25, v22, v5 row_newbcast:8 row_mask:0xf bank_mask:0xf
    v_and_b32_dpp v26, v22, v6 row_newbcast:8 row_mask:0xf bank_mask:0xf
    v_and_b32_dpp v27, v22, v7 row_newbcast:8 row_mask:0xf bank_mask:0xf
    v_mfma_f32_16x16x32_bf16 v[32:35], v[28:31], v[168:171], v[32:35]
    v_and_b32_dpp v28, v22, v4 row_newbcast:9 row_mask:0xf bank_mask:0xf
    v_and_b32_dpp v29, v22, v5 row_newbcast:9 row_mask:0xf bank_mask:0xf
    v_and_b32_dpp v30, v22, v6 row_newbcast:9 row_mask:0xf bank_mask:0xf
    v_and_b32_dpp v31, v22, v7 row_newbcast:9 row_mask:0xf bank_mask:0xf
    v_mfma_f32_16x16x32_bf16 v[32:35], v[24:27], v[172:175], v[32:35]
    v_and_b32_dpp v24, v22, v4 row_newbcast:10 row_mask:0xf bank_mask:0xf
    v_and_b32_dpp v25, v22, v5 row_newbcast:10 row_mask:0xf bank_mask:0xf
    v_and_b32_dpp v26, v22, v6 row_newbcast:10 row_mask:0xf bank_mask:0xf
    v_and_b32_dpp v27, v22, v7 row_newbcast:10 row_mask:0xf bank_mask:0xf
    v_mfma_f32_16x16x32_bf16 v[32:35], v[28:31], v[176:179], v[32:35]
    v_and_b32_dpp v28, v22, v4 row_newbcast:11 row_mask:0xf bank_mask:0xf
    v_and_b32_dpp v29, v22, v5 row_newbcast:11 row_mask:0xf bank_mask:0xf
    v_and_b32_dpp v30, v22, v6 row_newbcast:11 row_mask:0xf bank_mask:0xf
    v_and_b32_dpp v31, v22, v7 row_newbcast:11 row_mask:0xf bank_mask:0xf
    v_mfma_f32_16x16x32_bf16 v[32:35], v[24:27], v[180:183], v[32:35]
    v_and_b32_dpp v24, v22, v4 row_newbcast:12 row_mask:0xf bank_mask:0xf
    v_and_b32_dpp v25, v22, v5 row_newbcast:12 row_mask:0xf bank_mask:0xf
    v_and_b32_dpp v26, v22, v6 row_newbcast:12 row_mask:0xf bank_mask:0xf
    v_and_b32_dpp v27, v22, v7 row_newbcast:12 row_mask:0xf bank_mask:0xf
    v_mfma_f32_16x16x32_bf16 v[32:35], v[28:31], v[184:187], v[32:35]
    v_and_b32_dpp v28, v22, v4 row_newbcast:13 row_mask:0xf bank_mask:0xf
    v_and_b32_dpp v29, v22, v5 row_newbcast:13 row_mask:0xf bank_mask:0xf
    v_and_b32_dpp v30, v22, v6 row_newbcast:13 row_mask:0xf bank_mask:0xf
    v_and_b32_dpp v31, v22, v7 row_newbcast:13 row_mask:0xf bank_mask:0xf
    v_mfma_f32_16x16x32_bf16 v[32:35], v[24:27], v[188:191], v[32:35]
    v_and_b32_dpp v24, v22, v4 row_newbcast:14 row_mask:0xf bank_mask:0xf
    v_and_b32_dpp v25, v22, v5 row_newbcast:14 row_mask:0xf bank_mask:0xf
    v_and_b32_dpp v26, v22, v6 row_newbcast:14 row_mask:0xf bank_mask:0xf
    v_and_b32_dpp v27, v22, v7 row_newbcast:14 row_mask:0xf bank_mask:0xf
    v_mfma_f32_16x16x32_bf16 v[32:35], v[28:31], v[192:195], v[32:35]
    v_and_b32_dpp v28, v22, v4 row_newbcast:15 row_mask:0xf bank_mask:0xf
    v_and_b32_dpp v29, v22, v5 row_newbcast:15 row_mask:0xf bank_mask:0xf
    v_and_b32_dpp v30, v22, v6 row_newbcast:15 row_mask:0xf bank_mask:0xf
    v_and_b32_dpp v31, v22, v7 row_newbcast:15 row_mask:0xf bank_mask:0xf
    v_mfma_f32_16x16x32_bf16 v[32:35], v[24:27], v[196:199], v[32:35]
    s_nop 0
    v_mfma_f32_16x16x32_bf16 v[32:35], v[28:31], v[200:203], v[32:35]
    s_nop 7
    v_bfi_b32 v32, v8, s52, v32
    v_bfi_b32 v33, v8, s53, v33
    v_bfi_b32 v34, v8, s54, v34
    v_bfi_b32 v35, v8, s55, v35
    s_cmp_eq_u32 s0, 0
    s_cbranch_scc0 L_sn_20
    s_mov_b32 exec_lo, 0xffffffff
    s_mov_b32 exec_hi, 0x0
    buffer_store_dwordx4 v[32:35], v100, s[36:39], s18 offen offset:0
    s_mov_b64 exec, -1
    s_branch L_sf_21
L_sn_20:
    s_mov_b32 exec_lo, 0xffffffff
    s_mov_b32 exec_hi, 0x0
    s_add_u32 s1, s18, 786432
    buffer_store_dwordx4 v[32:35], v100, s[36:39], s1 offen offset:0 sc1
    s_mov_b64 exec, -1
    s_mov_b32 exec_lo, 0xffffffff
    s_mov_b32 exec_hi, 0x0
    buffer_store_dwordx4 v[32:35], v100, s[36:39], s18 offen offset:0 sc1
    s_mov_b64 exec, -1
L_sf_21:
L_nw_18:
    s_lshl_b32 s64, s14, 8
    s_sub_u32 s64, 20480, s64
    s_waitcnt vmcnt(0)
    v_and_b32 v24, v15, v4
    v_and_b32 v25, v15, v5
    v_and_b32 v26, v15, v6
    v_and_b32 v27, v15, v7
    v_and_b32 v28, v16, v4
    v_and_b32 v29, v16, v5
    v_and_b32 v30, v16, v6
    v_and_b32 v31, v16, v7
    v_mfma_f32_16x16x32_bf16 v[36:39], v[24:27], v[204:207], 0
    s_nop 0
    v_mfma_f32_16x16x32_bf16 v[36:39], v[28:31], v[208:211], v[36:39]
    s_mov_b32 exec_lo, 0x00ff00ff
    s_mov_b32 exec_hi, 0xff00ff00
    s_nop 5
    ds_write_b128 v13, v[36:39] offset:4096
    s_mov_b64 exec, -1
    s_waitcnt lgkmcnt(0)
    s_barrier
    s_add_u32 s65, s33, s64
    s_cmp_eq_u32 s48, 0
    s_cbranch_scc0 L_fb_22
    ds_read2st64_b32 v[80:81], v78 offset0:16 offset1:17
    ds_read2st64_b32 v[82:83], v78 offset0:18 offset1:19
    ds_read2st64_b32 v[84:85], v78 offset0:20 offset1:21
    ds_read2st64_b32 v[86:87], v78 offset0:22 offset1:23
    ds_read2st64_b32 v[88:89], v78 offset0:24 offset1:25
    ds_read2st64_b32 v[90:91], v78 offset0:26 offset1:27
    ds_read2st64_b32 v[92:93], v78 offset0:28 offset1:29
    ds_read2st64_b32 v[94:95], v78 offset0:30 offset1:31
    s_waitcnt lgkmcnt(0)
    v_add_f32 v80, v80, v81
    v_add_f32 v82, v82, v83
    v_add_f32 v84, v84, v85
    v_add_f32 v86, v86, v87
    v_add_f32 v88, v88, v89
    v_add_f32 v90, v90, v91
    v_add_f32 v92, v92, v93
    v_add_f32 v94, v94, v95
    v_add_f32 v80, v80, v82
    v_add_f32 v84, v84, v86
    v_add_f32 v88, v88, v90
    v_add_f32 v92, v92, v94
    v_add_f32 v80, v80, v84
    v_add_f32 v88, v88, v92
    v_add_f32 v80, v80, v88
    v_bfi_b32 v80, v8, v9, v80
    buffer_store_dword v80, v14, s[36:39], s65 offen sc1
L_fb_22:
    s_cmp_eq_u32 s48, 0
    s_cbranch_scc1 L_nw_23
    s_add_u32 s1, s18, 786432
    s_mov_b32 exec_hi, 0
    buffer_store_dwordx4 v[32:35], v100, s[36:39], s1 offen sc1
    s_mov_b32 exec_hi, -1
L_nw_23:
    s_branch L_fin
L_Q_pre:
    s_lshl_b32 s66, s50, 7
    s_and_b32 s61, s48, 3
    s_lshl_b32 s61, s61, 5
    s_add_u32 s66, s66, s61
    s_lshl_b32 s61, s51, 9
    s_lshr_b32 s60, s48, 2
    s_lshl_b32 s60, s60, 8
    s_add_u32 s61, s61, s60
    s_lshl_b32 s60, s66, 13
    s_add_u32 s60, s60, s61
    v_mul_u32_u24 v97, 8192, v3
    v_lshl_add_u32 v97, v2, 4, v97
    v_add_u32 v97, s60, v97
    s_mov_b32 s42, 8388608
    s_mov_b32 s43, 0x00020000
    s_waitcnt lgkmcnt(0)
    s_mov_b32 s40, s14
    s_mov_b32 s41, s15
    s_mov_b32 s44, s8
    s_mov_b32 s45, s9
    buffer_load_dwordx4 v[52:55], v48, s[44:47], 0 offen
    buffer_load_dwordx4 v[56:59], v48, s[44:47], 0 offen offset:16
    s_lshl_b32 s61, s66, 1
    buffer_load_ushort v60, v49, s[44:47], s61 offen
    s_and_b32 s61, s48, 1
    s_lshl_b32 s11, s51, 1
    s_add_u32 s11, s11, s61
    s_lshl_b32 s61, s11, 6
    buffer_load_ushort v76, v49, s[44:47], s61 offen
    s_mov_b32 s44, s26
    s_mov_b32 s45, s27
    buffer_load_dword v44, v42, s[44:47], s62 offen
    s_barrier
    buffer_load_dwordx4 v[108:111], v97, s[40:43], 0 offen nt
    s_mov_b32 s69, 32768
    buffer_load_dwordx4 v[112:115], v97, s[40:43], s69 offen nt
    s_mov_b32 s68, 65536
    buffer_load_dwordx4 v[116:119], v97, s[40:43], s68 offen nt
    s_mov_b32 s69, 98304
    buffer_load_dwordx4 v[120:123], v97, s[40:43], s69 offen nt
    s_mov_b32 s68, 131072
    buffer_load_dwordx4 v[124:127], v97, s[40:43], s68 offen nt
    s_mov_b32 s69, 163840
    buffer_load_dwordx4 v[128:131], v97, s[40:43], s69 offen nt
    s_mov_b32 s68, 196608
    buffer_load_dwordx4 v[132:135], v97, s[40:43], s68 offen nt
    s_mov_b32 s69, 229376
    buffer_load_dwordx4 v[136:139], v97, s[40:43], s69 offen nt
    s_mov_b32 s4, s28
    s_mov_b32 s5, s29
    s_load_dword s56, s[34:35], 0
    s_mov_b32 s36, s34
    s_mov_b32 s37, s35
    s_mov_b32 s38, 2621440
    s_mov_b32 s39, 0x00020000
    s_getreg_b32 s60, hwreg(HW_REG_XCC_ID, 0, 4)
    s_cmp_eq_u32 s60, s50
    s_cselect_b32 s0, 0, 786432
    v_and_b32 v40, 1, v1
    v_mov_b32 v41, 0xffff
    v_lshlrev_b32 v40, 4, v40
    v_lshlrev_b32 v41, v40, v41
    v_bfe_u32 v40, v1, 1, 2
    v_cmp_eq_u32 vcc, 0, v40
    s_nop 1
    v_cndmask_b32 v4, 0, v41, vcc
    v_cmp_eq_u32 vcc, 1, v40
    s_nop 1
    v_cndmask_b32 v5, 0, v41, vcc
    v_cmp_eq_u32 vcc, 2, v40
    s_nop 1
    v_cndmask_b32 v6, 0, v41, vcc
    v_cmp_eq_u32 vcc, 3, v40
    s_nop 1
    v_cndmask_b32 v7, 0, v41, vcc
    v_mov_b32 v8, 0xff
    v_mov_b32 v77, 1.0
    v_add_u32 v107, 82432, v14
    s_lshl_b32 s60, s48, 9
    s_add_u32 s60, s60, 65536
    v_lshlrev_b32 v12, 5, v2
    v_lshl_add_u32 v12, v3, 4, v12
    v_add_u32 v12, s60, v12
    v_and_b32 v40, 7, v1
    v_lshlrev_b32 v13, 5, v40
    v_and_b32 v41, 1, v3
    v_lshl_add_u32 v13, v41, 4, v13
    v_lshrrev_b32 v41, 1, v3
    v_lshl_add_u32 v13, v41, 8, v13
    v_add_u32 v13, s60, v13
    s_and_b32 s3, s48, 1
    s_lshl_b32 s3, s3, 8
    s_lshr_b32 s32, s48, 1
    s_add_u32 s60, s3, 65536
    v_add_u32 v78, s60, v14
    s_mul_i32 s33, s64, 24576
    s_add_u32 s33, s33, 790528
    v_mul_u32_u24 v79, 24576, v3
    v_bfe_u32 v41, v1, 3, 1
    v_lshl_add_u32 v79, v41, 12, v79
    v_lshl_add_u32 v79, v40, 4, v79
    s_waitcnt lgkmcnt(0)
    s_xor_b32 s56, s56, 2641058359
    s_bfe_u32 s52, s56, 524288
    s_bfe_u32 s53, s56, 524296
    s_bfe_u32 s54, s56, 524304
    s_bfe_u32 s55, s56, 524312
    s_lshr_b32 s57, s56, 16
    v_mov_b32 v0, s56
    v_and_b32 v40, 3, v1
    v_lshlrev_b32 v40, 3, v40
    v_bfe_u32 v9, v0, v40, 8
    v_lshlrev_b32 v40, 3, v3
    v_bfe_u32 v10, v0, v40, 8
    s_waitcnt vmcnt(8)
    v_lshlrev_b32 v40, 16, v44
    v_and_b32 v41, 0xffff0000, v44
    v_mul_f32 v42, 0xbfb8aa3b, v40
    v_exp_f32 v42, v42
    s_nop 0
    v_add_f32 v42, 1.0, v42
    v_rcp_f32 v42, v42
    s_nop 0
    v_mul_f32 v40, v40, v42
    v_mul_f32 v43, 0xbfb8aa3b, v41
    v_exp_f32 v43, v43
    s_nop 0
    v_add_f32 v43, 1.0, v43
    v_rcp_f32 v43, v43
    s_nop 0
    v_mul_f32 v41, v41, v43
    v_cvt_pk_bf16_f32 v15, v40, v40
    v_cvt_pk_bf16_f32 v16, v41, v41
    v_lshlrev_b32 v204, 16, v52
    v_and_b32 v205, 0xffff0000, v52
    v_lshlrev_b32 v206, 16, v53
    v_and_b32 v207, 0xffff0000, v53
    v_lshlrev_b32 v208, 16, v54
    v_and_b32 v209, 0xffff0000, v54
    v_lshlrev_b32 v210, 16, v55
    v_and_b32 v211, 0xffff0000, v55
    v_lshlrev_b32 v212, 16, v56
    v_and_b32 v213, 0xffff0000, v56
    v_lshlrev_b32 v214, 16, v57
    v_and_b32 v215, 0xffff0000, v57
    v_lshlrev_b32 v216, 16, v58
    v_and_b32 v217, 0xffff0000, v58
    v_lshlrev_b32 v218, 16, v59
    v_and_b32 v219, 0xffff0000, v59
    v_lshlrev_b32 v60, 16, v60
    v_add_f32 v40, v204, v205
    v_add_f32 v40, v40, v206
    v_add_f32 v40, v40, v207
    v_add_f32 v40, v40, v208
    v_add_f32 v40, v40, v209
    v_add_f32 v40, v40, v210
    v_add_f32 v40, v40, v211
    v_add_f32 v40, v40, v212
    v_add_f32 v40, v40, v213
    v_add_f32 v40, v40, v214
    v_add_f32 v40, v40, v215
    v_add_f32 v40, v40, v216
    v_add_f32 v40, v40, v217
    v_add_f32 v40, v40, v218
    v_add_f32 v40, v40, v219
    s_nop 1
    v_add_f32_dpp v40, v40, v40 quad_perm:[1,0,3,2] row_mask:0xf bank_mask:0xf
    s_nop 1
    v_add_f32_dpp v40, v40, v40 quad_perm:[2,3,0,1] row_mask:0xf bank_mask:0xf
    s_nop 1
    v_add_f32_dpp v40, v40, v40 row_half_mirror row_mask:0xf bank_mask:0xf
    s_nop 1
    v_add_f32_dpp v40, v40, v40 row_mirror row_mask:0xf bank_mask:0xf
    v_mov_b32 v41, v40
    s_nop 1
    v_permlane16_swap_b32 v40, v41
    v_add_f32 v40, v40, v41
    v_mov_b32 v41, v40
    s_nop 1
    v_permlane32_swap_b32 v40, v41
    v_add_f32 v40, v40, v41
    v_mul_f32 v40, 0x3a800000, v40
    v_mov_b32 v42, 0
    v_sub_f32 v204, v204, v40
    v_fmac_f32 v42, v204, v204
    v_sub_f32 v205, v205, v40
    v_fmac_f32 v42, v205, v205
    v_sub_f32 v206, v206, v40
    v_fmac_f32 v42, v206, v206
    v_sub_f32 v207, v207, v40
    v_fmac_f32 v42, v207, v207
    v_sub_f32 v208, v208, v40
    v_fmac_f32 v42, v208, v208
    v_sub_f32 v209, v209, v40
    v_fmac_f32 v42, v209, v209
    v_sub_f32 v210, v210, v40
    v_fmac_f32 v42, v210, v210
    v_sub_f32 v211, v211, v40
    v_fmac_f32 v42, v211, v211
    v_sub_f32 v212, v212, v40
    v_fmac_f32 v42, v212, v212
    v_sub_f32 v213, v213, v40
    v_fmac_f32 v42, v213, v213
    v_sub_f32 v214, v214, v40
    v_fmac_f32 v42, v214, v214
    v_sub_f32 v215, v215, v40
    v_fmac_f32 v42, v215, v215
    v_sub_f32 v216, v216, v40
    v_fmac_f32 v42, v216, v216
    v_sub_f32 v217, v217, v40
    v_fmac_f32 v42, v217, v217
    v_sub_f32 v218, v218, v40
    v_fmac_f32 v42, v218, v218
    v_sub_f32 v219, v219, v40
    v_fmac_f32 v42, v219, v219
    s_nop 1
    v_add_f32_dpp v42, v42, v42 quad_perm:[1,0,3,2] row_mask:0xf bank_mask:0xf
    s_nop 1
    v_add_f32_dpp v42, v42, v42 quad_perm:[2,3,0,1] row_mask:0xf bank_mask:0xf
    s_nop 1
    v_add_f32_dpp v42, v42, v42 row_half_mirror row_mask:0xf bank_mask:0xf
    s_nop 1
    v_add_f32_dpp v42, v42, v42 row_mirror row_mask:0xf bank_mask:0xf
    v_mov_b32 v41, v42
    s_nop 1
    v_permlane16_swap_b32 v42, v41
    v_add_f32 v42, v42, v41
    v_mov_b32 v41, v42
    s_nop 1
    v_permlane32_swap_b32 v42, v41
    v_add_f32 v42, v42, v41
    v_mul_f32 v42, 0x3a800000, v42
    v_cvt_pk_bf16_f32 v42, v42, v42
    v_and_b32 v42, 0xffff0000, v42
    v_cvt_pk_bf16_f32 v40, v40, v40
    v_and_b32 v40, 0xffff0000, v40
    v_add_f32 v42, 925353388, v42
    v_cvt_pk_bf16_f32 v42, v42, v42
    v_and_b32 v42, 0xffff0000, v42
    v_sqrt_f32 v42, v42
    s_nop 0
    v_cvt_pk_bf16_f32 v42, v42, v42
    v_and_b32 v42, 0xffff0000, v42
    v_rcp_f32 v42, v42
    v_sub_f32 v41, v60, v40
    v_cvt_pk_bf16_f32 v41, v41, v41
    v_and_b32 v41, 0xffff0000, v41
    v_mul_f32 v41, v41, v42
    v_cvt_pk_bf16_f32 v23, v41, v41
    v_and_b32 v23, 0xffff0000, v23
    s_lshl_b32 s60, s51, 7
    s_add_u32 s60, s60, s58
    s_add_u32 s60, s60, 4096
    v_add_u32 v253, s60, v11
    s_lshl_b32 s60, s51, 7
    s_add_u32 s60, s60, s58
    s_add_u32 s60, s60, 10240
    v_add_u32 v101, s60, v11
    s_mov_b32 s44, s24
    s_mov_b32 s45, s25
    s_mov_b32 s46, 7340032
    s_mov_b32 s47, 0x00020000
    s_and_b32 s60, s51, 1
    s_mul_i32 s62, s60, 224
    s_mul_i32 s61, s48, 28
    s_add_u32 s62, s62, s61
    s_mul_i32 s61, s50, 448
    s_add_u32 s64, s62, s61
    s_lshl_b32 s64, s64, 11
    s_lshr_b32 s63, s51, 1
    s_lshl_b32 s61, s63, 8
    s_add_u32 s64, s64, s61
    v_mul_u32_u24 v100, 2048, v3
    v_lshl_add_u32 v100, v2, 4, v100
    v_add_u32 v100, s64, v100
    s_lshl_b32 s12, s62, 2
    s_mul_i32 s61, s50, 57344
    s_add_u32 s12, s12, s61
    s_add_u32 s12, s12, 331776
    s_add_u32 s12, s12, s0
    s_lshl_b32 s13, s50, 1
    s_add_u32 s13, s13, s60
    s_lshl_b32 s13, s13, 12
    s_lshl_b32 s61, s63, 9
    s_add_u32 s13, s13, s61
    s_add_u32 s13, s13, 2363392
    s_lshl_b32 s10, s50, 13
    s_lshl_b32 s63, s11, 8
    s_add_u32 s10, s10, s63
    s_add_u32 s10, s10, 200704
    s_lshl_b32 s60, s66, 2
    s_add_u32 s60, s60, 4096
    s_add_u32 s60, s60, s0
    s_add_u32 s61, s60, 98304
    s_lshl_b32 s64, s50, 14
    s_lshl_b32 s63, s51, 10
    s_add_u32 s64, s64, s63
    s_lshl_b32 s63, s48, 8
    s_add_u32 s64, s64, s63
    s_add_u32 s64, s64, 1576960
    s_lshl_b32 s63, s32, 11
    v_add_u32 v74, s63, v78
    s_mov_b32 s40, s16
    s_mov_b32 s41, s17
    s_mov_b32 s42, 8388608
    s_mov_b32 s43, 0x00020000
    s_and_b32 s66, s49, 31
    s_lshr_b32 s67, s49, 5
    s_lshr_b32 s63, s66, 3
    s_lshl_b32 s62, s63, 10
    s_and_b32 s63, s66, 7
    s_lshl_b32 s63, s63, 4
    s_add_u32 s62, s62, s63
    s_and_b32 s63, s48, 3
    s_lshl_b32 s63, s63, 2
    s_add_u32 s62, s62, s63
    s_lshl_b32 s62, s62, 11
    s_lshl_b32 s63, s67, 9
    s_add_u32 s62, s62, s63
    s_lshr_b32 s63, s48, 2
    s_lshl_b32 s63, s63, 8
    s_add_u32 s62, s62, s63
    v_mul_u32_u24 v252, 2048, v3
    v_lshl_add_u32 v252, v2, 4, v252
    v_add_u32 v252, s62, v252
    s_waitcnt vmcnt(0)
    buffer_load_dwordx4 v[40:43], v79, s[36:39], s60 offen sc1
    buffer_load_dwordx4 v[44:47], v79, s[36:39], s61 offen sc1
    s_waitcnt vmcnt(0)
L_h1_w_25:
    v_xor_b32 v40, s52, v40
    v_xor_b32 v41, s53, v41
    v_xor_b32 v42, s54, v42
    v_xor_b32 v43, s55, v43
    v_xor_b32 v44, s52, v44
    v_xor_b32 v45, s53, v45
    v_xor_b32 v46, s54, v46
    v_xor_b32 v47, s55, v47
    v_or_b32 v21, v40, v41
    v_or3_b32 v21, v21, v42, v43
    v_or3_b32 v21, v21, v44, v45
    v_or3_b32 v21, v21, v46, v47
    v_and_b32 v21, 0xff, v21
    v_cmp_ne_u32 vcc, 0, v21
    s_cbranch_vccz L_h1_d_26
    s_mov_b64 exec, vcc
    s_sleep 2
    buffer_load_dwordx4 v[40:43], v79, s[36:39], s60 offen sc1
    buffer_load_dwordx4 v[44:47], v79, s[36:39], s61 offen sc1
    s_sub_u32 s70, s70, 1
    s_waitcnt vmcnt(0)
    s_cbranch_scc0 L_h1_w_25
    s_mov_b32 s70, 0
L_h1_d_26:
    s_mov_b64 exec, -1
    v_add_f32 v40, v40, v44
    v_add_f32 v41, v41, v45
    v_add_f32 v42, v42, v46
    v_add_f32 v43, v43, v47
    s_nop 0
    v_permlane32_swap_b32 v40, v42
    v_permlane32_swap_b32 v41, v43
    v_add_f32 v40, v40, v42
    v_add_f32 v41, v41, v43
    s_nop 1
    v_permlane16_swap_b32 v40, v41
    v_add_f32 v40, v40, v41
    v_cvt_pk_bf16_f32 v254, v40, v40
    v_and_b32 v254, 0xffff0000, v254
    s_nop 1
    v_add_f32_dpp v255, v254, v77 row_ror:8 row_mask:0xf bank_mask:0xf
    v_cvt_pk_bf16_f32 v255, v255, v255
    v_and_b32 v255, 0xffff0000, v255
    v_mul_f32 v41, v23, v255
    v_cvt_pk_bf16_f32 v41, v41, v41
    v_and_b32 v41, 0xffff0000, v41
    v_add_f32 v41, v41, v254
    v_cvt_pk_bf16_f32 v22, v41, v41
    s_nop 1
    v_and_b32_dpp v24, v22, v4 row_newbcast:0 row_mask:0xf bank_mask:0xf
    v_and_b32_dpp v25, v22, v5 row_newbcast:0 row_mask:0xf bank_mask:0xf
    v_and_b32_dpp v26, v22, v6 row_newbcast:0 row_mask:0xf bank_mask:0xf
    v_and_b32_dpp v27, v22, v7 row_newbcast:0 row_mask:0xf bank_mask:0xf
    v_and_b32_dpp v28, v22, v4 row_newbcast:1 row_mask:0xf bank_mask:0xf
    v_and_b32_dpp v29, v22, v5 row_newbcast:1 row_mask:0xf bank_mask:0xf
    v_and_b32_dpp v30, v22, v6 row_newbcast:1 row_mask:0xf bank_mask:0xf
    v_and_b32_dpp v31, v22, v7 row_newbcast:1 row_mask:0xf bank_mask:0xf
    v_mfma_f32_16x16x32_bf16 v[32:35], v[24:27], v[108:111], 0
    v_and_b32_dpp v24, v22, v4 row_newbcast:2 row_mask:0xf bank_mask:0xf
    v_and_b32_dpp v25, v22, v5 row_newbcast:2 row_mask:0xf bank_mask:0xf
    v_and_b32_dpp v26, v22, v6 row_newbcast:2 row_mask:0xf bank_mask:0xf
    v_and_b32_dpp v27, v22, v7 row_newbcast:2 row_mask:0xf bank_mask:0xf
    v_mfma_f32_16x16x32_bf16 v[32:35], v[28:31], v[112:115], v[32:35]
    v_and_b32_dpp v28, v22, v4 row_newbcast:3 row_mask:0xf bank_mask:0xf
    v_and_b32_dpp v29, v22, v5 row_newbcast:3 row_mask:0xf bank_mask:0xf
    v_and_b32_dpp v30, v22, v6 row_newbcast:3 row_mask:0xf bank_mask:0xf
    v_and_b32_dpp v31, v22, v7 row_newbcast:3 row_mask:0xf bank_mask:0xf
    v_mfma_f32_16x16x32_bf16 v[32:35], v[24:27], v[116:119], v[32:35]
    v_and_b32_dpp v24, v22, v4 row_newbcast:4 row_mask:0xf bank_mask:0xf
    v_and_b32_dpp v25, v22, v5 row_newbcast:4 row_mask:0xf bank_mask:0xf
    v_and_b32_dpp v26, v22, v6 row_newbcast:4 row_mask:0xf bank_mask:0xf
    v_and_b32_dpp v27, v22, v7 row_newbcast:4 row_mask:0xf bank_mask:0xf
    v_mfma_f32_16x16x32_bf16 v[32:35], v[28:31], v[120:123], v[32:35]
    v_and_b32_dpp v28, v22, v4 row_newbcast:5 row_mask:0xf bank_mask:0xf
    v_and_b32_dpp v29, v22, v5 row_newbcast:5 row_mask:0xf bank_mask:0xf
    v_and_b32_dpp v30, v22, v6 row_newbcast:5 row_mask:0xf bank_mask:0xf
    v_and_b32_dpp v31, v22, v7 row_newbcast:5 row_mask:0xf bank_mask:0xf
    v_mfma_f32_16x16x32_bf16 v[32:35], v[24:27], v[124:127], v[32:35]
    v_and_b32_dpp v24, v22, v4 row_newbcast:6 row_mask:0xf bank_mask:0xf
    v_and_b32_dpp v25, v22, v5 row_newbcast:6 row_mask:0xf bank_mask:0xf
    v_and_b32_dpp v26, v22, v6 row_newbcast:6 row_mask:0xf bank_mask:0xf
    v_and_b32_dpp v27, v22, v7 row_newbcast:6 row_mask:0xf bank_mask:0xf
    v_mfma_f32_16x16x32_bf16 v[32:35], v[28:31], v[128:131], v[32:35]
    v_and_b32_dpp v28, v22, v4 row_newbcast:7 row_mask:0xf bank_mask:0xf
    v_and_b32_dpp v29, v22, v5 row_newbcast:7 row_mask:0xf bank_mask:0xf
    v_and_b32_dpp v30, v22, v6 row_newbcast:7 row_mask:0xf bank_mask:0xf
    v_and_b32_dpp v31, v22, v7 row_newbcast:7 row_mask:0xf bank_mask:0xf
    v_mfma_f32_16x16x32_bf16 v[32:35], v[24:27], v[132:135], v[32:35]
    s_nop 0
    v_mfma_f32_16x16x32_bf16 v[32:35], v[28:31], v[136:139], v[32:35]
    s_mov_b32 exec_hi, 0
    s_nop 6
    ds_write_b128 v12, v[32:35] offset:8192
    s_mov_b32 exec_hi, -1
    s_waitcnt lgkmcnt(0)
    s_barrier
    s_cmp_lt_u32 s48, 4
    s_cbranch_scc0 L_f2_27
    ds_read2st64_b32 v[80:81], v74 offset0:32 offset1:34
    ds_read2st64_b32 v[82:83], v74 offset0:36 offset1:38
    s_waitcnt lgkmcnt(0)
    v_add_f32 v80, v80, v81
    v_add_f32 v82, v82, v83
    v_add_f32 v80, v80, v82
    v_bfi_b32 v80, v8, v9, v80
    buffer_store_dword v80, v14, s[36:39], s64 offen sc1
    s_cmp_eq_u32 s48, 0
    s_cbranch_scc0 L_f2_27
    s_xor_b32 s68, s2, 8
    s_lshl_b32 s68, s68, 7
    s_add_u32 s68, s68, 2428928
    s_mov_b64 exec, 1
    buffer_store_dword v0, v14, s[36:39], s68 offen sc1
    s_mov_b64 exec, -1
L_f2_27:
    s_barrier
    buffer_load_dwordx4 v[204:207], v253, s[4:7], 0 offen nt
    s_mov_b32 s69, 12288
    buffer_load_dwordx4 v[208:211], v253, s[4:7], s69 offen nt
    buffer_load_dwordx4 v[140:143], v252, s[40:43], 0 offen nt
    s_mov_b32 s69, 262144
    buffer_load_dwordx4 v[144:147], v252, s[40:43], s69 offen nt
    s_mov_b32 s68, 524288
    buffer_load_dwordx4 v[148:151], v252, s[40:43], s68 offen nt
    s_mov_b32 s69, 786432
    buffer_load_dwordx4 v[152:155], v252, s[40:43], s69 offen nt
    s_mov_b32 s68, 1048576
    buffer_load_dwordx4 v[156:159], v252, s[40:43], s68 offen nt
    s_mov_b32 s69, 1310720
    buffer_load_dwordx4 v[160:163], v252, s[40:43], s69 offen nt
    s_mov_b32 s68, 1572864
    buffer_load_dwordx4 v[164:167], v252, s[40:43], s68 offen nt
    s_mov_b32 s69, 1835008
    buffer_load_dwordx4 v[168:171], v252, s[40:43], s69 offen nt
    s_and_b32 s61, s48, 3
    s_lshl_b32 s61, s61, 8
    s_add_u32 s61, s61, 82432
    v_add_u32 v73, s61, v14
    v_lshrrev_b32 v68, 3, v1
    v_and_b32 v69, 7, v1
    v_lshlrev_b32 v71, 11, v68
    v_lshl_add_u32 v71, v69, 4, v71
    s_lshl_b32 s62, s66, 14
    s_lshl_b32 s61, s48, 7
    s_add_u32 s62, s62, s61
    s_add_u32 s62, s62, 1708032
    s_lshl_b32 s59, s66, 12
    s_lshl_b32 s61, s67, 10
    s_add_u32 s59, s59, s61
    s_lshl_b32 s61, s48, 8
    s_add_u32 s59, s59, s61
    s_add_u32 s59, s59, 2232320
    s_waitcnt vmcnt(8)
    v_and_b32 v24, v15, v4
    v_and_b32 v25, v15, v5
    v_and_b32 v26, v15, v6
    v_and_b32 v27, v15, v7
    v_and_b32 v28, v16, v4
    v_and_b32 v29, v16, v5
    v_and_b32 v30, v16, v6
    v_and_b32 v31, v16, v7
    v_mfma_f32_16x16x32_bf16 v[32:35], v[24:27], v[204:207], 0
    s_nop 0
    v_mfma_f32_16x16x32_bf16 v[32:35], v[28:31], v[208:211], v[32:35]
    s_mov_b32 exec_lo, 0x00ff00ff
    s_mov_b32 exec_hi, 0xff00ff00
    s_nop 5
    ds_write_b128 v13, v[32:35] offset:4096
    s_mov_b64 exec, -1
    s_waitcnt lgkmcnt(0)
    s_barrier
    s_lshl_b32 s64, s51, 8
    s_add_u32 s64, s64, 8192
    s_add_u32 s65, s33, s64
    s_cmp_eq_u32 s48, 4
    s_cbranch_scc0 L_fb_28
    ds_read2st64_b32 v[80:81], v78 offset0:16 offset1:17
    ds_read2st64_b32 v[82:83], v78 offset0:18 offset1:19
    ds_read2st64_b32 v[84:85], v78 offset0:20 offset1:21
    ds_read2st64_b32 v[86:87], v78 offset0:22 offset1:23
    ds_read2st64_b32 v[88:89], v78 offset0:24 offset1:25
    ds_read2st64_b32 v[90:91], v78 offset0:26 offset1:27
    ds_read2st64_b32 v[92:93], v78 offset0:28 offset1:29
    ds_read2st64_b32 v[94:95], v78 offset0:30 offset1:31
    s_waitcnt lgkmcnt(0)
    v_add_f32 v80, v80, v81
    v_add_f32 v82, v82, v83
    v_add_f32 v84, v84, v85
    v_add_f32 v86, v86, v87
    v_add_f32 v88, v88, v89
    v_add_f32 v90, v90, v91
    v_add_f32 v92, v92, v93
    v_add_f32 v94, v94, v95
    v_add_f32 v80, v80, v82
    v_add_f32 v84, v84, v86
    v_add_f32 v88, v88, v90
    v_add_f32 v92, v92, v94
    v_add_f32 v80, v80, v84
    v_add_f32 v88, v88, v92
    v_add_f32 v80, v80, v88
    v_bfi_b32 v80, v8, v9, v80
    buffer_store_dword v80, v14, s[36:39], s65 offen sc1
L_fb_28:
    s_mov_b32 s61, 0x04000c0c
    s_mov_b32 s63, 0x0706000c
    s_cmp_eq_u32 s48, 0
    s_cbranch_scc0 L_gated_30
    s_lshl_b32 s68, s2, 7
    s_add_u32 s68, s68, 2461696
L_gate_29:
    s_buffer_load_dword s69, s[36:39], s68 glc
    s_waitcnt lgkmcnt(0)
    s_cmp_eq_u32 s69, s56
    s_cbranch_scc1 L_gated_30
    s_sub_u32 s70, s70, 1
    s_cbranch_scc0 L_gate_29
    s_mov_b32 s70, 0
L_gated_30:
    s_waitcnt lgkmcnt(0)
    s_barrier
    s_cmp_lt_u32 s48, 4
    s_cbranch_scc0 L_s4_wait
    buffer_load_dwordx4 v[40:43], v71, s[36:39], s62 offen offset:0 sc1
    buffer_load_dwordx4 v[44:47], v71, s[36:39], s62 offen offset:512 sc1
    buffer_load_dwordx4 v[48:51], v71, s[36:39], s62 offen offset:1024 sc1
    buffer_load_dwordx4 v[52:55], v71, s[36:39], s62 offen offset:1536 sc1
    s_waitcnt vmcnt(0)
L_h3_w_31:
    v_xor_b32 v40, v9, v40
    v_xor_b32 v44, v9, v44
    v_xor_b32 v48, v9, v48
    v_xor_b32 v52, v9, v52
    v_or_b32 v21, v40, v44
    v_or3_b32 v21, v21, v48, v52
    v_and_b32 v21, 0xff, v21
    v_cmp_ne_u32 vcc, 0, v21
    s_cbranch_vccz L_h3_d_32
    buffer_load_dwordx4 v[40:43], v71, s[36:39], s62 offen offset:0 sc1
    buffer_load_dwordx4 v[44:47], v71, s[36:39], s62 offen offset:512 sc1
    buffer_load_dwordx4 v[48:51], v71, s[36:39], s62 offen offset:1024 sc1
    buffer_load_dwordx4 v[52:55], v71, s[36:39], s62 offen offset:1536 sc1
    s_sub_u32 s70, s70, 1
    s_waitcnt vmcnt(0)
    s_cbranch_scc0 L_h3_w_31
    s_mov_b32 s70, 0
L_h3_d_32:
    v_perm_b32 v56, v41, v42, s61
    v_perm_b32 v57, v45, v46, s61
    v_perm_b32 v58, v49, v50, s61
    v_perm_b32 v59, v53, v54, s61
    v_perm_b32 v56, v56, v43, s63
    v_perm_b32 v57, v57, v47, s63
    v_perm_b32 v58, v58, v51, s63
    v_perm_b32 v59, v59, v55, s63
    v_max3_f32 v64, v56, v57, v58
    v_max_f32 v64, v64, v59
    s_nop 1
    v_max_f32_dpp v64, v64, v64 row_ror:8 row_mask:0xf bank_mask:0xf
    v_mov_b32 v65, v64
    s_nop 1
    v_permlane16_swap_b32 v64, v65
    v_max_f32 v64, v64, v65
    v_mov_b32 v65, v64
    s_nop 1
    v_permlane32_swap_b32 v64, v65
    v_max_f32 v64, v64, v65
    v_sub_f32 v56, v56, v64
    v_sub_f32 v57, v57, v64
    v_sub_f32 v58, v58, v64
    v_sub_f32 v59, v59, v64
    v_exp_f32 v56, v56
    v_exp_f32 v57, v57
    v_exp_f32 v58, v58
    v_exp_f32 v59, v59
    v_add_f32 v64, v56, v57
    v_add_f32 v65, v58, v59
    v_mul_f32 v40, v56, v40
    v_mul_f32 v41, v56, v41
    v_mul_f32 v42, v56, v42
    v_mul_f32 v43, v56, v43
    v_add_f32 v64, v64, v65
    v_fmac_f32 v40, v57, v44
    v_fmac_f32 v41, v57, v45
    v_fmac_f32 v42, v57, v46
    v_fmac_f32 v43, v57, v47
    v_add_f32_dpp v64, v64, v64 row_ror:8 row_mask:0xf bank_mask:0xf
    v_fmac_f32 v40, v58, v48
    v_fmac_f32 v41, v58, v49
    v_fmac_f32 v42, v58, v50
    v_fmac_f32 v43, v58, v51
    v_fmac_f32 v40, v59, v52
    v_fmac_f32 v41, v59, v53
    v_fmac_f32 v42, v59, v54
    v_fmac_f32 v43, v59, v55
    v_mov_b32 v65, v64
    s_nop 1
    v_permlane16_swap_b32 v64, v65
    v_add_f32 v64, v64, v65
    v_mov_b32 v65, v64
    s_nop 1
    v_permlane32_swap_b32 v64, v65
    v_add_f32 v64, v64, v65
    v_rcp_f32 v64, v64
    v_permlane32_swap_b32 v40, v42
    v_permlane32_swap_b32 v41, v43
    v_add_f32 v40, v40, v42
    v_add_f32 v41, v41, v43
    s_nop 1
    v_permlane16_swap_b32 v40, v41
    v_add_f32 v40, v40, v41
    s_nop 1
    v_add_f32_dpp v40, v40, v40 row_ror:8 row_mask:0xf bank_mask:0xf
    v_mul_f32 v40, v40, v64
    v_cvt_pk_bf16_f32 v22, v40, v40
    ds_write_b32 v73, v22
L_s4_wait:
    s_waitcnt vmcnt(0)
    s_waitcnt lgkmcnt(0)
    s_barrier
    ds_read_b32 v22, v73
    buffer_load_dwordx4 v[172:175], v100, s[44:47], 0 offen nt
    s_mov_b32 s69, 8192
    buffer_load_dwordx4 v[176:179], v100, s[44:47], s69 offen nt
    s_waitcnt lgkmcnt(0)
    v_and_b32_dpp v24, v22, v4 row_newbcast:0 row_mask:0xf bank_mask:0xf
    v_and_b32_dpp v25, v22, v5 row_newbcast:0 row_mask:0xf bank_mask:0xf
    v_and_b32_dpp v26, v22, v6 row_newbcast:0 row_mask:0xf bank_mask:0xf
    v_and_b32_dpp v27, v22, v7 row_newbcast:0 row_mask:0xf bank_mask:0xf
    v_and_b32_dpp v28, v22, v4 row_newbcast:1 row_mask:0xf bank_mask:0xf
    v_and_b32_dpp v29, v22, v5 row_newbcast:1 row_mask:0xf bank_mask:0xf
    v_and_b32_dpp v30, v22, v6 row_newbcast:1 row_mask:0xf bank_mask:0xf
    v_and_b32_dpp v31, v22, v7 row_newbcast:1 row_mask:0xf bank_mask:0xf
    v_mfma_f32_16x16x32_bf16 v[32:35], v[24:27], v[140:143], 0
    v_and_b32_dpp v24, v22, v4 row_newbcast:2 row_mask:0xf bank_mask:0xf
    v_and_b32_dpp v25, v22, v5 row_newbcast:2 row_mask:0xf bank_mask:0xf
    v_and_b32_dpp v26, v22, v6 row_newbcast:2 row_mask:0xf bank_mask:0xf
    v_and_b32_dpp v27, v22, v7 row_newbcast:2 row_mask:0xf bank_mask:0xf
    v_mfma_f32_16x16x32_bf16 v[32:35], v[28:31], v[144:147], v[32:35]
    v_and_b32_dpp v28, v22, v4 row_newbcast:3 row_mask:0xf bank_mask:0xf
    v_and_b32_dpp v29, v22, v5 row_newbcast:3 row_mask:0xf bank_mask:0xf
    v_and_b32_dpp v30, v22, v6 row_newbcast:3 row_mask:0xf bank_mask:0xf
    v_and_b32_dpp v31, v22, v7 row_newbcast:3 row_mask:0xf bank_mask:0xf
    v_mfma_f32_16x16x32_bf16 v[32:35], v[24:27], v[148:151], v[32:35]
    v_and_b32_dpp v24, v22, v4 row_newbcast:4 row_mask:0xf bank_mask:0xf
    v_and_b32_dpp v25, v22, v5 row_newbcast:4 row_mask:0xf bank_mask:0xf
    v_and_b32_dpp v26, v22, v6 row_newbcast:4 row_mask:0xf bank_mask:0xf
    v_and_b32_dpp v27, v22, v7 row_newbcast:4 row_mask:0xf bank_mask:0xf
    v_mfma_f32_16x16x32_bf16 v[32:35], v[28:31], v[152:155], v[32:35]
    v_and_b32_dpp v28, v22, v4 row_newbcast:5 row_mask:0xf bank_mask:0xf
    v_and_b32_dpp v29, v22, v5 row_newbcast:5 row_mask:0xf bank_mask:0xf
    v_and_b32_dpp v30, v22, v6 row_newbcast:5 row_mask:0xf bank_mask:0xf
    v_and_b32_dpp v31, v22, v7 row_newbcast:5 row_mask:0xf bank_mask:0xf
    v_mfma_f32_16x16x32_bf16 v[32:35], v[24:27], v[156:159], v[32:35]
    v_and_b32_dpp v24, v22, v4 row_newbcast:6 row_mask:0xf bank_mask:0xf
    v_and_b32_dpp v25, v22, v5 row_newbcast:6 row_mask:0xf bank_mask:0xf
    v_and_b32_dpp v26, v22, v6 row_newbcast:6 row_mask:0xf bank_mask:0xf
    v_and_b32_dpp v27, v22, v7 row_newbcast:6 row_mask:0xf bank_mask:0xf
    v_mfma_f32_16x16x32_bf16 v[32:35], v[28:31], v[160:163], v[32:35]
    v_and_b32_dpp v28, v22, v4 row_newbcast:7 row_mask:0xf bank_mask:0xf
    v_and_b32_dpp v29, v22, v5 row_newbcast:7 row_mask:0xf bank_mask:0xf
    v_and_b32_dpp v30, v22, v6 row_newbcast:7 row_mask:0xf bank_mask:0xf
    v_and_b32_dpp v31, v22, v7 row_newbcast:7 row_mask:0xf bank_mask:0xf
    v_mfma_f32_16x16x32_bf16 v[32:35], v[24:27], v[164:167], v[32:35]
    s_nop 0
    v_mfma_f32_16x16x32_bf16 v[32:35], v[28:31], v[168:171], v[32:35]
    s_mov_b32 exec_hi, 0
    s_nop 6
    ds_write_b128 v12, v[32:35] offset:0
    s_mov_b32 exec_hi, -1
    s_waitcnt lgkmcnt(0)
    s_barrier
    s_cmp_lt_u32 s48, 4
    s_cbranch_scc0 L_f4_33
    ds_read2st64_b32 v[80:81], v74 offset0:0 offset1:2
    ds_read2st64_b32 v[82:83], v74 offset0:4 offset1:6
    s_waitcnt lgkmcnt(0)
    v_add_f32 v80, v80, v81
    v_add_f32 v82, v82, v83
    v_add_f32 v80, v80, v82
    v_bfi_b32 v80, v8, v9, v80
    buffer_store_dword v80, v14, s[36:39], s59 offen sc1
L_f4_33:
    s_cmp_lt_u32 s48, 4
    s_cbranch_scc0 L_s5_done
    s_cmp_lt_u32 s48, 2
    s_cbranch_scc1 L_s5_x1
    s_lshl_b32 s65, s11, 7
    s_add_u32 s68, s65, 802816
    s_add_u32 s69, s68, 98304
    buffer_load_dwordx4 v[40:43], v79, s[36:39], s68 offen sc1
    buffer_load_dwordx4 v[44:47], v79, s[36:39], s69 offen sc1
    s_waitcnt vmcnt(0)
L_md_w_34:
    v_xor_b32 v40, s52, v40
    v_xor_b32 v41, s53, v41
    v_xor_b32 v42, s54, v42
    v_xor_b32 v43, s55, v43
    v_xor_b32 v44, s52, v44
    v_xor_b32 v45, s53, v45
    v_xor_b32 v46, s54, v46
    v_xor_b32 v47, s55, v47
    v_or_b32 v21, v40, v41
    v_or3_b32 v21, v21, v42, v43
    v_or3_b32 v21, v21, v44, v45
    v_or3_b32 v21, v21, v46, v47
    v_and_b32 v21, 0xff, v21
    v_cmp_ne_u32 vcc, 0, v21
    s_cbranch_vccz L_md_d_35
    s_mov_b64 exec, vcc
    s_sleep 4
    buffer_load_dwordx4 v[40:43], v79, s[36:39], s68 offen sc1
    buffer_load_dwordx4 v[44:47], v79, s[36:39], s69 offen sc1
    s_sub_u32 s70, s70, 1
    s_waitcnt vmcnt(0)
    s_cbranch_scc0 L_md_w_34
    s_mov_b32 s70, 0
L_md_d_35:
    s_mov_b64 exec, -1
    v_add_f32 v40, v40, v44
    v_add_f32 v41, v41, v45
    v_add_f32 v42, v42, v46
    v_add_f32 v43, v43, v47
    s_nop 0
    v_permlane32_swap_b32 v40, v42
    v_permlane32_swap_b32 v41, v43
    v_add_f32 v40, v40, v42
    v_add_f32 v41, v41, v43
    s_nop 1
    v_permlane16_swap_b32 v40, v41
    v_add_f32 v40, v40, v41
    v_cvt_pk_bf16_f32 v254, v40, v40
    v_and_b32 v254, 0xffff0000, v254
    s_nop 1
    v_add_f32_dpp v255, v254, v77 row_ror:8 row_mask:0xf bank_mask:0xf
    v_cvt_pk_bf16_f32 v255, v255, v255
    v_and_b32 v255, 0xffff0000, v255
    v_or_b32 v254, v10, v254
    v_or_b32 v255, v10, v255
    s_add_u32 s65, s10, 65536
    s_cmp_eq_u32 s0, 0
    s_cbranch_scc0 L_sn_36
    s_mov_b32 exec_lo, 0xff00ff
    s_mov_b32 exec_hi, 0xff00ff
    buffer_store_dword v254, v96, s[36:39], s65 offen offset:0
    buffer_store_dword v255, v96, s[36:39], s65 offen offset:128
    s_mov_b64 exec, -1
L_sn_36:
    s_mov_b32 exec_lo, 0xff00ff
    s_mov_b32 exec_hi, 0xff00ff
    s_add_u32 s1, s65, 786432
    buffer_store_dword v254, v96, s[36:39], s1 offen offset:0 sc1
    s_add_u32 s1, s65, 786432
    buffer_store_dword v255, v96, s[36:39], s1 offen offset:128 sc1
    s_mov_b64 exec, -1
    s_cmp_eq_u32 s0, 0
    s_cbranch_scc1 L_sf_37
    s_mov_b32 exec_lo, 0xff00ff
    s_mov_b32 exec_hi, 0xff00ff
    buffer_store_dword v254, v96, s[36:39], s65 offen offset:0 sc1
    buffer_store_dword v255, v96, s[36:39], s65 offen offset:128 sc1
    s_mov_b64 exec, -1
L_sf_37:
    s_branch L_s5_done
L_s5_x1:
    v_lshrrev_b32 v67, 3, v1
    v_and_b32 v68, 7, v1
    v_lshlrev_b32 v68, 4, v68
    v_lshl_add_u32 v64, v67, 12, v68
    s_lshl_b32 s65, s11, 7
    s_add_u32 s60, s65, 2232320
    s_add_u32 s61, s60, 32768
    s_add_u32 s62, s60, 65536
    s_add_u32 s63, s60, 98304
    s_add_u32 s64, s65, 798720
    v_lshlrev_b32 v76, 16, v76
    v_mov_b32 v61, s56
    v_mov_b32 v63, s56
    s_waitcnt vmcnt(0)
    buffer_load_dwordx4 v[40:43], v64, s[36:39], s60 offen sc1
    buffer_load_dwordx4 v[44:47], v64, s[36:39], s61 offen sc1
    buffer_load_dwordx4 v[48:51], v64, s[36:39], s62 offen sc1
    buffer_load_dwordx4 v[52:55], v64, s[36:39], s63 offen sc1
    buffer_load_dwordx4 v[56:59], v11, s[36:39], s64 offen sc1
    s_waitcnt vmcnt(0)
L_h4_w_38:
    v_xor_b32 v40, s52, v40
    v_xor_b32 v41, s53, v41
    v_xor_b32 v42, s54, v42
    v_xor_b32 v43, s55, v43
    v_xor_b32 v44, s52, v44
    v_xor_b32 v45, s53, v45
    v_xor_b32 v46, s54, v46
    v_xor_b32 v47, s55, v47
    v_xor_b32 v48, s52, v48
    v_xor_b32 v49, s53, v49
    v_xor_b32 v50, s54, v50
    v_xor_b32 v51, s55, v51
    v_xor_b32 v52, s52, v52
    v_xor_b32 v53, s53, v53
    v_xor_b32 v54, s54, v54
    v_xor_b32 v55, s55, v55
    v_xor_b32 v56, s52, v56
    v_xor_b32 v57, s53, v57
    v_xor_b32 v58, s54, v58
    v_xor_b32 v59, s55, v59
    v_or_b32 v21, v40, v41
    v_or3_b32 v21, v21, v42, v43
    v_or3_b32 v21, v21, v44, v45
    v_or3_b32 v21, v21, v46, v47
    v_or3_b32 v21, v21, v48, v49
    v_or3_b32 v21, v21, v50, v51
    v_or3_b32 v21, v21, v52, v53
    v_or3_b32 v21, v21, v54, v55
    v_or3_b32 v21, v21, v56, v57
    v_or3_b32 v21, v21, v58, v59
    v_and_b32 v21, 0xff, v21
    v_cmp_ne_u32 vcc, 0, v21
    s_cbranch_vccz L_h4_d_39
    s_mov_b64 exec, vcc
    buffer_load_dwordx4 v[40:43], v64, s[36:39], s60 offen sc1
    buffer_load_dwordx4 v[44:47], v64, s[36:39], s61 offen sc1
    buffer_load_dwordx4 v[48:51], v64, s[36:39], s62 offen sc1
    buffer_load_dwordx4 v[52:55], v64, s[36:39], s63 offen sc1
    buffer_load_dwordx4 v[56:59], v11, s[36:39], s64 offen sc1
    s_sub_u32 s70, s70, 1
    s_waitcnt vmcnt(0)
    s_cbranch_scc0 L_h4_w_38
    s_mov_b32 s70, 0
L_h4_d_39:
    s_mov_b64 exec, -1
    v_add_f32 v40, v40, v44
    v_add_f32 v48, v48, v52
    v_add_f32 v41, v41, v45
    v_add_f32 v49, v49, v53
    v_add_f32 v42, v42, v46
    v_add_f32 v50, v50, v54
    v_add_f32 v43, v43, v47
    v_add_f32 v51, v51, v55
    v_add_f32 v40, v40, v48
    v_add_f32 v41, v41, v49
    v_add_f32 v42, v42, v50
    v_add_f32 v43, v43, v51
    s_nop 0
    v_permlane32_swap_b32 v40, v42
    v_permlane32_swap_b32 v41, v43
    v_permlane32_swap_b32 v56, v58
    v_permlane32_swap_b32 v57, v59
    v_add_f32 v40, v40, v42
    v_add_f32 v41, v41, v43
    v_add_f32 v56, v56, v58
    v_add_f32 v57, v57, v59
    v_permlane16_swap_b32 v40, v41
    s_nop 0
    v_permlane16_swap_b32 v56, v57
    v_add_f32 v40, v40, v41
    v_add_f32 v56, v56, v57
    s_nop 0
    v_add_f32_dpp v40, v40, v40 row_ror:8 row_mask:0xf bank_mask:0xf
    v_add_f32_dpp v56, v56, v56 row_ror:8 row_mask:0xf bank_mask:0xf
    v_cvt_pk_bf16_f32 v40, v40, v40
    v_and_b32 v40, 0xffff0000, v40
    v_cvt_pk_bf16_f32 v56, v56, v56
    v_and_b32 v56, 0xffff0000, v56
    v_mul_f32 v40, v40, v56
    v_cvt_pk_bf16_f32 v40, v40, v40
    v_and_b32 v40, 0xffff0000, v40
    v_add_f32 v40, v40, v76
    v_cvt_pk_bf16_f32 v40, v40, v40
    v_and_b32 v40, 0xffff0000, v40
    v_or_b32 v41, v10, v40
    v_mov_b32 v60, v40
    v_mul_f32 v62, v40, v40
    s_nop 0
    v_add_f32_dpp v60, v60, v60 quad_perm:[1,0,3,2] row_mask:0xf bank_mask:0xf
    v_add_f32_dpp v62, v62, v62 quad_perm:[1,0,3,2] row_mask:0xf bank_mask:0xf
    s_nop 0
    v_add_f32_dpp v60, v60, v60 quad_perm:[2,3,0,1] row_mask:0xf bank_mask:0xf
    v_add_f32_dpp v62, v62, v62 quad_perm:[2,3,0,1] row_mask:0xf bank_mask:0xf
    s_nop 0
    v_add_f32_dpp v60, v60, v60 row_half_mirror row_mask:0xf bank_mask:0xf
    v_add_f32_dpp v62, v62, v62 row_half_mirror row_mask:0xf bank_mask:0xf
    s_nop 0
    v_add_f32_dpp v60, v60, v60 row_mirror row_mask:0xf bank_mask:0xf
    v_add_f32_dpp v62, v62, v62 row_mirror row_mask:0xf bank_mask:0xf
    v_mov_b32 v42, v60
    v_mov_b32 v43, v62
    s_nop 0
    v_permlane16_swap_b32 v60, v42
    v_permlane16_swap_b32 v62, v43
    v_add_f32 v60, v60, v42
    v_add_f32 v62, v62, v43
    v_mov_b32 v42, v60
    v_mov_b32 v43, v62
    s_nop 0
    v_permlane32_swap_b32 v60, v42
    v_permlane32_swap_b32 v62, v43
    v_add_f32 v60, v60, v42
    v_add_f32 v62, v62, v43
    s_cmp_eq_u32 s0, 0
    s_cbranch_scc0 L_sn_40
    s_mov_b32 exec_lo, 0xff00ff
    s_mov_b32 exec_hi, 0xff00ff
    buffer_store_dword v41, v96, s[36:39], s10 offen offset:0
    s_mov_b64 exec, 1
    buffer_store_dwordx4 v[60:63], v14, s[36:39], s10 offen offset:128
    s_mov_b64 exec, -1
L_sn_40:
    s_mov_b32 exec_lo, 0xff00ff
    s_mov_b32 exec_hi, 0xff00ff
    s_add_u32 s1, s10, 786432
    buffer_store_dword v41, v96, s[36:39], s1 offen offset:0 sc1
    s_mov_b64 exec, 1
    s_add_u32 s1, s10, 786432
    buffer_store_dwordx4 v[60:63], v14, s[36:39], s1 offen offset:128 sc1
    s_mov_b64 exec, -1
    s_cmp_eq_u32 s0, 0
    s_cbranch_scc1 L_sf_41
    s_mov_b32 exec_lo, 0xff00ff
    s_mov_b32 exec_hi, 0xff00ff
    buffer_store_dword v41, v96, s[36:39], s10 offen offset:0 sc1
    s_mov_b64 exec, 1
    buffer_store_dwordx4 v[60:63], v14, s[36:39], s10 offen offset:128 sc1
    s_mov_b64 exec, -1
L_sf_41:
L_s5_done:
    s_barrier
    s_mov_b32 s68, 16384
    buffer_load_dwordx4 v[180:183], v100, s[44:47], s68 offen nt
    s_mov_b32 s69, 24576
    buffer_load_dwordx4 v[184:187], v100, s[44:47], s69 offen nt
    s_mov_b32 s68, 32768
    buffer_load_dwordx4 v[188:191], v100, s[44:47], s68 offen nt
    s_mov_b32 s69, 40960
    buffer_load_dwordx4 v[192:195], v100, s[44:47], s69 offen nt
    s_mov_b32 s68, 49152
    buffer_load_dwordx4 v[196:199], v100, s[44:47], s68 offen nt
    v_mul_u32_u24 v64, 3584, v3
    v_bfe_u32 v65, v1, 3, 1
    v_mul_u32_u24 v65, 1792, v65
    v_add_u32 v64, v64, v65
    v_and_b32 v65, 7, v1
    v_min_u32 v65, 6, v65
    v_lshl_add_u32 v64, v65, 4, v64
    s_add_u32 s60, s12, 14336
    s_add_u32 s61, s12, 28672
    s_add_u32 s62, s12, 43008
    s_waitcnt vmcnt(0)
    buffer_load_dwordx4 v[40:43], v64, s[36:39], s12 offen sc1
    buffer_load_dwordx4 v[44:47], v64, s[36:39], s60 offen sc1
    buffer_load_dwordx4 v[48:51], v64, s[36:39], s61 offen sc1
    buffer_load_dwordx4 v[52:55], v64, s[36:39], s62 offen sc1
    s_waitcnt vmcnt(0)
L_h5_w_42:
    v_xor_b32 v40, s52, v40
    v_xor_b32 v41, s53, v41
    v_xor_b32 v42, s54, v42
    v_xor_b32 v43, s55, v43
    v_xor_b32 v44, s52, v44
    v_xor_b32 v45, s53, v45
    v_xor_b32 v46, s54, v46
    v_xor_b32 v47, s55, v47
    v_xor_b32 v48, s52, v48
    v_xor_b32 v49, s53, v49
    v_xor_b32 v50, s54, v50
    v_xor_b32 v51, s55, v51
    v_xor_b32 v52, s52, v52
    v_xor_b32 v53, s53, v53
    v_xor_b32 v54, s54, v54
    v_xor_b32 v55, s55, v55
    v_or_b32 v21, v40, v41
    v_or3_b32 v21, v21, v42, v43
    v_or3_b32 v21, v21, v44, v45
    v_or3_b32 v21, v21, v46, v47
    v_or3_b32 v21, v21, v48, v49
    v_or3_b32 v21, v21, v50, v51
    v_or3_b32 v21, v21, v52, v53
    v_or3_b32 v21, v21, v54, v55
    v_and_b32 v21, 0xff, v21
    v_cmp_ne_u32 vcc, 0, v21
    s_cbranch_vccz L_h5_d_43
    s_mov_b64 exec, vcc
    s_sleep 2
    buffer_load_dwordx4 v[40:43], v64, s[36:39], s12 offen sc1
    buffer_load_dwordx4 v[44:47], v64, s[36:39], s60 offen sc1
    buffer_load_dwordx4 v[48:51], v64, s[36:39], s61 offen sc1
    buffer_load_dwordx4 v[52:55], v64, s[36:39], s62 offen sc1
    s_sub_u32 s70, s70, 1
    s_waitcnt vmcnt(0)
    s_cbranch_scc0 L_h5_w_42
    s_mov_b32 s70, 0
L_h5_d_43:
    s_mov_b64 exec, -1
    v_add_f32 v40, v40, v48
    v_add_f32 v41, v41, v49
    v_add_f32 v42, v42, v50
    v_add_f32 v43, v43, v51
    v_add_f32 v44, v44, v52
    v_add_f32 v45, v45, v53
    v_add_f32 v46, v46, v54
    v_add_f32 v47, v47, v55
    v_add_f32 v40, v40, v44
    v_add_f32 v41, v41, v45
    v_add_f32 v42, v42, v46
    v_add_f32 v43, v43, v47
    s_nop 0
    v_permlane32_swap_b32 v40, v42
    v_permlane32_swap_b32 v41, v43
    v_add_f32 v40, v40, v42
    v_add_f32 v41, v41, v43
    s_nop 1
    v_permlane16_swap_b32 v40, v41
    v_add_f32 v40, v40, v41
    v_cvt_pk_bf16_f32 v40, v40, v40
    v_and_b32 v40, 0xffff0000, v40
    v_mul_f32 v43, 0xbfb8aa3b, v40
    v_exp_f32 v43, v43
    s_nop 0
    v_add_f32 v43, 1.0, v43
    v_rcp_f32 v43, v43
    s_nop 0
    v_mul_f32 v42, v40, v43
    v_cvt_pk_bf16_f32 v42, v42, v42
    v_and_b32 v42, 0xffff0000, v42
    s_nop 1
    v_mul_f32_dpp v42, v40, v42 row_ror:8 row_mask:0xf bank_mask:0xf
    v_cvt_pk_bf16_f32 v22, v42, v42
    s_nop 1
    v_and_b32_dpp v24, v22, v4 row_newbcast:0 row_mask:0xf bank_mask:0xf
    v_and_b32_dpp v25, v22, v5 row_newbcast:0 row_mask:0xf bank_mask:0xf
    v_and_b32_dpp v26, v22, v6 row_newbcast:0 row_mask:0xf bank_mask:0xf
    v_and_b32_dpp v27, v22, v7 row_newbcast:0 row_mask:0xf bank_mask:0xf
    v_and_b32_dpp v28, v22, v4 row_newbcast:1 row_mask:0xf bank_mask:0xf
    v_and_b32_dpp v29, v22, v5 row_newbcast:1 row_mask:0xf bank_mask:0xf
    v_and_b32_dpp v30, v22, v6 row_newbcast:1 row_mask:0xf bank_mask:0xf
    v_and_b32_dpp v31, v22, v7 row_newbcast:1 row_mask:0xf bank_mask:0xf
    v_mfma_f32_16x16x32_bf16 v[32:35], v[24:27], v[172:175], 0
    v_and_b32_dpp v24, v22, v4 row_newbcast:2 row_mask:0xf bank_mask:0xf
    v_and_b32_dpp v25, v22, v5 row_newbcast:2 row_mask:0xf bank_mask:0xf
    v_and_b32_dpp v26, v22, v6 row_newbcast:2 row_mask:0xf bank_mask:0xf
    v_and_b32_dpp v27, v22, v7 row_newbcast:2 row_mask:0xf bank_mask:0xf
    v_mfma_f32_16x16x32_bf16 v[32:35], v[28:31], v[176:179], v[32:35]
    v_and_b32_dpp v28, v22, v4 row_newbcast:3 row_mask:0xf bank_mask:0xf
    v_and_b32_dpp v29, v22, v5 row_newbcast:3 row_mask:0xf bank_mask:0xf
    v_and_b32_dpp v30, v22, v6 row_newbcast:3 row_mask:0xf bank_mask:0xf
    v_and_b32_dpp v31, v22, v7 row_newbcast:3 row_mask:0xf bank_mask:0xf
    v_mfma_f32_16x16x32_bf16 v[32:35], v[24:27], v[180:183], v[32:35]
    v_and_b32_dpp v24, v22, v4 row_newbcast:4 row_mask:0xf bank_mask:0xf
    v_and_b32_dpp v25, v22, v5 row_newbcast:4 row_mask:0xf bank_mask:0xf
    v_and_b32_dpp v26, v22, v6 row_newbcast:4 row_mask:0xf bank_mask:0xf
    v_and_b32_dpp v27, v22, v7 row_newbcast:4 row_mask:0xf bank_mask:0xf
    v_mfma_f32_16x16x32_bf16 v[32:35], v[28:31], v[184:187], v[32:35]
    v_and_b32_dpp v28, v22, v4 row_newbcast:5 row_mask:0xf bank_mask:0xf
    v_and_b32_dpp v29, v22, v5 row_newbcast:5 row_mask:0xf bank_mask:0xf
    v_and_b32_dpp v30, v22, v6 row_newbcast:5 row_mask:0xf bank_mask:0xf
    v_and_b32_dpp v31, v22, v7 row_newbcast:5 row_mask:0xf bank_mask:0xf
    v_mfma_f32_16x16x32_bf16 v[32:35], v[24:27], v[188:191], v[32:35]
    v_and_b32_dpp v24, v22, v4 row_newbcast:6 row_mask:0xf bank_mask:0xf
    v_and_b32_dpp v25, v22, v5 row_newbcast:6 row_mask:0xf bank_mask:0xf
    v_and_b32_dpp v26, v22, v6 row_newbcast:6 row_mask:0xf bank_mask:0xf
    v_and_b32_dpp v27, v22, v7 row_newbcast:6 row_mask:0xf bank_mask:0xf
    v_mfma_f32_16x16x32_bf16 v[32:35], v[28:31], v[192:195], v[32:35]
    s_nop 0
    v_mfma_f32_16x16x32_bf16 v[32:35], v[24:27], v[196:199], v[32:35]
    s_mov_b32 exec_hi, 0
    s_nop 6
    ds_write_b128 v12, v[32:35] offset:8192
    s_mov_b32 exec_hi, -1
    s_waitcnt lgkmcnt(0)
    s_barrier
    s_add_u32 s65, s3, s13
    s_cmp_eq_u32 s32, 0
    s_cbranch_scc0 L_fa_44
    ds_read2st64_b32 v[80:81], v78 offset0:32 offset1:34
    ds_read2st64_b32 v[82:83], v78 offset0:36 offset1:38
    ds_read2st64_b32 v[84:85], v78 offset0:40 offset1:42
    ds_read2st64_b32 v[86:87], v78 offset0:44 offset1:46
    s_waitcnt lgkmcnt(0)
    v_add_f32 v80, v80, v81
    v_add_f32 v82, v82, v83
    v_add_f32 v84, v84, v85
    v_add_f32 v86, v86, v87
    v_add_f32 v80, v80, v82
    v_add_f32 v84, v84, v86
    v_add_f32 v80, v80, v84
    v_bfi_b32 v80, v8, v9, v80
    buffer_store_dword v80, v14, s[36:39], s65 offen sc1
L_fa_44:
    s_cmp_lt_u32 s49, 32
    s_cbranch_scc0 L_fin
    s_cmp_eq_u32 s48, 0
    s_cbranch_scc0 L_fin
    v_lshrrev_b32 v67, 3, v1
    v_and_b32 v68, 7, v1
    v_lshlrev_b32 v68, 4, v68
    v_lshl_add_u32 v64, v67, 12, v68
    s_lshl_b32 s63, s49, 7
    s_add_u32 s60, s63, 2363392
    s_add_u32 s61, s60, 32768
    s_add_u32 s62, s63, 811008
    s_lshl_b32 s63, s49, 8
    s_lshl_b32 s64, s50, 13
    s_add_u32 s63, s63, s64
    s_add_u32 s63, s63, 200704
    s_add_u32 s63, s63, s0
    s_mov_b32 s40, s30
    s_mov_b32 s41, s31
    s_mov_b32 s42, 2048
    s_mov_b32 s43, 0x00020000
    v_lshrrev_b32 v66, 1, v96
    s_lshl_b32 s64, s49, 6
    s_waitcnt vmcnt(0)
    buffer_load_dwordx4 v[40:43], v64, s[36:39], s60 offen sc1
    buffer_load_dwordx4 v[44:47], v64, s[36:39], s61 offen sc1
    buffer_load_dwordx4 v[48:51], v11, s[36:39], s62 offen sc1
    buffer_load_dword v52, v96, s[36:39], s63 offen sc1
    s_waitcnt vmcnt(0)
L_h6_w_45:
    v_xor_b32 v40, s52, v40
    v_xor_b32 v41, s53, v41
    v_xor_b32 v42, s54, v42
    v_xor_b32 v43, s55, v43
    v_xor_b32 v44, s52, v44
    v_xor_b32 v45, s53, v45
    v_xor_b32 v46, s54, v46
    v_xor_b32 v47, s55, v47
    v_xor_b32 v48, s52, v48
    v_xor_b32 v49, s53, v49
    v_xor_b32 v50, s54, v50
    v_xor_b32 v51, s55, v51
    v_xor_b32 v52, v10, v52
    v_or3_b32 v21, v40, v41, v42
    v_or3_b32 v21, v21, v43, v44
    v_or3_b32 v21, v21, v45, v46
    v_or3_b32 v21, v21, v47, v48
    v_or3_b32 v21, v21, v49, v50
    v_or3_b32 v21, v21, v51, v52
    v_and_b32 v21, 0xff, v21
    v_cmp_ne_u32 vcc, 0, v21
    s_cbranch_vccz L_h6_d_46
    buffer_load_dwordx4 v[40:43], v64, s[36:39], s60 offen sc1
    buffer_load_dwordx4 v[44:47], v64, s[36:39], s61 offen sc1
    buffer_load_dwordx4 v[48:51], v11, s[36:39], s62 offen sc1
    buffer_load_dword v52, v96, s[36:39], s63 offen sc1
    s_sub_u32 s70, s70, 1
    s_waitcnt vmcnt(0)
    s_cbranch_scc0 L_h6_w_45
    s_mov_b32 s70, 0
L_h6_d_46:
    v_add_f32 v40, v40, v44
    v_add_f32 v41, v41, v45
    v_add_f32 v42, v42, v46
    v_add_f32 v43, v43, v47
    s_nop 0
    v_permlane32_swap_b32 v40, v42
    v_permlane32_swap_b32 v41, v43
    v_permlane32_swap_b32 v48, v50
    v_permlane32_swap_b32 v49, v51
    v_add_f32 v40, v40, v42
    v_add_f32 v41, v41, v43
    v_add_f32 v48, v48, v50
    v_add_f32 v49, v49, v51
    v_permlane16_swap_b32 v40, v41
    s_nop 0
    v_permlane16_swap_b32 v48, v49
    v_add_f32 v40, v40, v41
    v_add_f32 v48, v48, v49
    s_nop 0
    v_add_f32_dpp v40, v40, v40 row_ror:8 row_mask:0xf bank_mask:0xf
    v_add_f32_dpp v48, v48, v48 row_ror:8 row_mask:0xf bank_mask:0xf
    v_cvt_pk_bf16_f32 v40, v40, v40
    v_and_b32 v40, 0xffff0000, v40
    v_cvt_pk_bf16_f32 v48, v48, v48
    v_and_b32 v48, 0xffff0000, v48
    v_mul_f32 v40, v40, v48
    v_cvt_pk_bf16_f32 v40, v40, v40
    v_and_b32 v40, 0xffff0000, v40
    v_add_f32 v40, v40, v52
    v_cvt_pk_bf16_f32 v40, v40, v40
    s_mov_b32 exec_lo, 0x00ff00ff
    s_mov_b32 exec_hi, 0x00ff00ff
    buffer_store_short v40, v66, s[40:43], s64 offen
    s_mov_b64 exec, -1
    s_cmp_eq_u32 s49, 0
    s_cbranch_scc0 L_fin
    s_mov_b64 exec, 1
    buffer_store_dword v0, v14, s[36:39], 0 offen offset:0
    s_mov_b64 exec, -1
L_fin:
L_end:
    s_endpgm
.section .rodata,"a"
.p2align 6
.amdhsa_kernel adaLN_cond__sliding_block_cached__swiglu_ffn__decode_kernel
  .amdhsa_next_free_vgpr 256
  .amdhsa_next_free_sgpr 102
  .amdhsa_accum_offset 256
  .amdhsa_group_segment_fixed_size 0
  .amdhsa_kernarg_size 112
  .amdhsa_user_sgpr_count 2
  .amdhsa_user_sgpr_kernarg_segment_ptr 1
  .amdhsa_system_sgpr_workgroup_id_x 1
.end_amdhsa_kernel
```
